```python
import torch

def _softmax(x, axis=-1):
    return torch.softmax(x, dim=axis)
def _gelu(x):
    return torch.nn.functional.gelu(x, approximate="tanh")
def _silu(x):
    return torch.nn.functional.silu(x)
def _sigmoid(x):
    return torch.sigmoid(x)
def _layernorm(x, axis=-1, eps=1e-5):
    m = x.mean(dim=axis, keepdim=True)
    v = x.var(dim=axis, keepdim=True, unbiased=False)
    return (x - m) / torch.sqrt(v + eps)
def _scatter_add(tgt, idx, src, axis=0):
    return tgt.clone().index_add_(axis, idx, src)
def _segment_sum(src, seg, n):
    out = torch.zeros((n,) + src.shape[1:], dtype=src.dtype)
    return out.index_add_(0, seg, src)
def _pad(x, pw):
    flat = tuple(v for pair in reversed(pw) for v in pair)
    return torch.nn.functional.pad(x, flat)

kernel_name = 'sequential_preLN__ssm_conv_s4__glu_gated_bilinear__prompt'

def setup_inputs():

    _w = (lambda a: (lambda t: t.to(torch.bfloat16) if t.is_floating_point() else t)(torch.as_tensor(a)))
    def _A_setup():
        B, L, D, N = 1, 2048, 512, 128
        A_re = -(lambda _x: torch.exp(torch.as_tensor(_x)))((lambda *s: torch.randn(*s, dtype=torch.bfloat16) * 6.4)(D, N))
        A_im = torch.pi * (lambda *s: torch.randn(*s, dtype=torch.bfloat16) * 0.05)(D, N)
        B_re = (lambda *s: torch.randn(*s, dtype=torch.bfloat16) * 0.1)(D, N)
        B_im = (lambda *s: torch.randn(*s, dtype=torch.bfloat16) * 0.1)(D, N)
        C_re = (lambda *s: torch.randn(*s, dtype=torch.bfloat16) * 0.1)(D, N)
        C_im = (lambda *s: torch.randn(*s, dtype=torch.bfloat16) * 0.1)(D, N)
        log_dt = (lambda *s: torch.randn(*s, dtype=torch.bfloat16) * 0.05)(D) * 0.5 - 4.0
        Dskip = (lambda *s: torch.randn(*s, dtype=torch.bfloat16) * 0.05)(D)
        return {
            "u": _w((lambda *s: torch.randn(*s, dtype=torch.bfloat16) * 0.05)(B, L, D)),
            "A_re": _w(A_re),
            "A_im": _w(A_im),
            "B_re": _w(B_re),
            "B_im": _w(B_im),
            "C_re": _w(C_re),
            "C_im": _w(C_im),
            "log_dt": _w(log_dt),
            "Dskip": _w(Dskip),
        }
    _A_in = _A_setup()

    def _B_setup():
        B, S, D, F = 1, 2048, 512, 1792
        return {
            "x": _w((lambda *s: torch.randn(*s, dtype=torch.bfloat16) * 0.05)(B, S, D)),
            "w_gate": _w((lambda *s: torch.randn(*s, dtype=torch.bfloat16) * 0.4)(D, F) * (D ** -0.5)),
            "w_up": _w((lambda *s: torch.randn(*s, dtype=torch.bfloat16) * 0.4)(D, F) * (D ** -0.5)),
            "w_down": _w((lambda *s: torch.randn(*s, dtype=torch.bfloat16) * 0.4)(F, D) * (F ** -0.5)),
        }
    _B_in = _B_setup()

    return {
        "A_u": _A_in["u"],
        "A_A_re": _A_in["A_re"],
        "A_A_im": _A_in["A_im"],
        "A_B_re": _A_in["B_re"],
        "A_B_im": _A_in["B_im"],
        "A_C_re": _A_in["C_re"],
        "A_C_im": _A_in["C_im"],
        "A_log_dt": _A_in["log_dt"],
        "A_Dskip": _A_in["Dskip"],
        "B_x": _B_in["x"],
        "B_w_gate": _B_in["w_gate"],
        "B_w_up": _B_in["w_up"],
        "B_w_down": _B_in["w_down"],
    }

def reference(A_u, A_A_re, A_A_im, A_B_re, A_B_im, A_C_re, A_C_im, A_log_dt, A_Dskip, B_x, B_w_gate, B_w_up, B_w_down):
    def _A_ref(u, A_re, A_im, B_re, B_im, C_re, C_im, log_dt, Dskip):
        Bsz, L, D = u.shape
        dt = torch.exp(log_dt)[:, None]
        A = A_re + 1j * A_im
        Bc = B_re + 1j * B_im
        Cc = C_re + 1j * C_im
        logdA = dt * A
        dB = dt * Bc
        l = (lambda x, dt: x.to(dt))(torch.arange(L), A_re.dtype)
        P = torch.exp(logdA[:, :, None] * l[None, None, :])
        K = torch.einsum("dn,dnl,dn->dl", Cc, P, dB).real
        L2 = 2 * L
        Kp = _pad(K, ((0, 0), (0, L)))
        up = (lambda x, *d: x.permute(*d))(u, 0, 2, 1)
        up = _pad(up, ((0, 0), (0, 0), (0, L)))
        Kf = (lambda x, axes=(-2,-1): torch.fft.rfft2(x.float(), dim=axes))(Kp[:, None, :], axes=(-2, -1))
        Uf = (lambda x, axes=(-2,-1): torch.fft.rfft2(x.float(), dim=axes))(up[:, :, None, :], axes=(-2, -1))
        Yf = Uf * Kf[None, :, :, :]
        y = (lambda x, s, axes=(-2,-1): torch.fft.irfft2(x, s=s, dim=axes).to(torch.bfloat16))(Yf, (1, L2), axes=(-2, -1))[:, :, 0, :L]
        y = (lambda x, *d: x.permute(*d))(y, 0, 2, 1) + u * Dskip[None, None, :]
        return y

    def _B_ref(x, w_gate, w_up, w_down):
        g = torch.einsum("bsd,df->bsf", x, w_gate)
        u = torch.einsum("bsd,df->bsf", x, w_up)
        h = g * u
        return torch.einsum("bsf,fd->bsd", h, w_down)

    x = A_u
    h = x + _A_ref(_layernorm(x, axis=-1), A_A_re, A_A_im, A_B_re, A_B_im, A_C_re, A_C_im, A_log_dt, A_Dskip)
    h2 = h + _B_ref(_layernorm(h, axis=-1), B_w_gate, B_w_up, B_w_down)
    return h2
```

```asm
; @launch grid=(256,1,1) block=(512,1,1) lds=163840
.amdgcn_target "amdgcn-amd-amdhsa--gfx950"
.text
.globl sequential_preLN__ssm_conv_s4__glu_gated_bilinear__prompt_kernel
.p2align 8
.type sequential_preLN__ssm_conv_s4__glu_gated_bilinear__prompt_kernel,@function
sequential_preLN__ssm_conv_s4__glu_gated_bilinear__prompt_kernel:
  s_cmp_ge_u32 s2, 256
  s_cbranch_scc1 k_done
  s_load_dwordx16 s[16:31], s[0:1], 0
  s_load_dwordx16 s[32:47], s[0:1], 64
  s_getpc_b64 s[90:91]
k_pc:
  s_bfe_u32 s5, s2, 0x30003
  s_mul_i32 s5, s5, 5
  s_lshr_b32 s5, s5, 3
  s_lshl_b32 s5, s5, 13
  v_lshrrev_b32 v1, 3, v0
  v_lshl_add_u32 v1, v1, 7, s5
  v_min_u32 v1, k_end-k_pc-4, v1
  global_load_dword v254, v1, s[90:91]
  v_lshrrev_b32 v1, 6, v0
  s_nop 0
  v_readfirstlane_b32 s10, v1
  v_and_b32 v0, 255, v0
  s_and_b32 s14, s2, 7
  s_lshl_b32 s3, s14, 5
  s_lshr_b32 s5, s2, 3
  s_add_u32 s3, s3, s5
  s_mov_b32 s4, 0xffff0000
  s_and_b32 s11, s10, 3
  s_cmp_lt_u32 s10, 4
  s_cbranch_scc1 e_m
  s_setprio 2
  v_and_b32 v2, 63, v0
  v_lshrrev_b32 v28, 5, v2
  v_and_b32 v29, 31, v2
  v_lshlrev_b32 v3, 12, v28
  v_lshl_add_u32 v3, v29, 3, v3
  s_lshl_b32 s6, s2, 13
  s_lshl_b32 s7, s11, 8
  s_add_u32 s7, s7, s6
  v_add_u32 v3, s7, v3
  s_waitcnt lgkmcnt(0)
  global_load_dwordx2 v[16:17], v3, s[16:17] offset:0 nt
  global_load_dwordx2 v[18:19], v3, s[16:17] offset:1024 nt
  global_load_dwordx2 v[20:21], v3, s[16:17] offset:2048 nt
  global_load_dwordx2 v[22:23], v3, s[16:17] offset:3072 nt
  s_load_dword s48, s[46:47], 0xc000
  s_lshl_b32 s5, s3, 2
  s_load_dword s23, s[32:33], s5
  s_barrier
  s_branch e_h
e_m:
  s_lshl_b32 s5, s3, 9
  v_lshl_add_u32 v2, v0, 1, s5
  s_lshl_b32 s5, s3, 2
  v_mov_b32 v8, 0
  v_mov_b32 v9, 0
  v_mov_b32 v10, 0
  v_mov_b32 v11, 0
  v_mov_b32 v12, 0
  v_mov_b32 v13, 0
  v_mov_b32 v6, 163776
  ds_write_b128 v6, v[8:11]
  s_waitcnt lgkmcnt(0)
  global_load_short_d16_hi v8, v2, s[18:19] nt
  global_load_short_d16_hi v9, v2, s[20:21] nt
  global_load_short_d16_hi v10, v2, s[22:23] nt
  global_load_short_d16_hi v11, v2, s[24:25] nt
  global_load_short_d16_hi v12, v2, s[26:27] nt
  global_load_short_d16_hi v13, v2, s[28:29] nt
  s_load_dword s6, s[30:31], s5
  s_load_dword s48, s[46:47], 0xc000
  s_barrier
  s_branch m_main
e_h:
  v_lshrrev_b32 v24, 1, v29
  v_lshlrev_b32 v24, 8, v24
  v_and_b32 v25, 1, v29
  v_lshl_add_u32 v24, v25, 5, v24
  v_lshl_add_u32 v24, v28, 4, v24
  s_lshr_b32 s6, s2, 1
  s_mul_i32 s6, s6, 16384
  s_and_b32 s7, s2, 1
  s_lshl_b32 s7, s7, 6
  s_add_u32 s6, s6, s7
  s_lshl_b32 s7, s11, 12
  s_add_u32 s6, s6, s7
  s_add_u32 s6, s6, 0x80000
  v_add_u32 v24, s6, v24
  v_bfe_u32 v25, v2, 2, 2
  v_bfe_u32 v26, v2, 4, 1
  v_lshl_add_u32 v25, v25, 1, v26
  v_lshl_add_u32 v25, v28, 3, v25
  s_lshl_b32 s7, s11, 6
  s_add_u32 s7, s7, 159744
  v_lshl_add_u32 v25, v25, 2, s7
  v_and_b32 v27, 3, v2
  v_lshlrev_b32 v27, 4, v27
  v_add_u32 v26, 159744, v27
  s_lshl_b32 s6, s2, 6
  s_add_u32 s6, s6, 0x0
  v_add_u32 v27, s6, v27
  v_mov_b32 v30, 163776
  v_mov_b32 v31, 1
  s_and_b32 s50, s2, 3
  s_lshr_b32 s15, s2, 5
  s_bfe_u32 s34, s2, 0x20003
  s_and_b32 s12, s2, 4
  s_add_u32 s12, s12, s34
  s_mul_i32 s13, s50, 7
  s_add_u32 s13, s13, s15
  s_mov_b32 s49, s15
  s_and_b32 s5, s15, 3
  s_cmp_eq_u32 s5, 3
  s_cselect_b32 s5, 4, 0
  s_xor_b32 s15, s15, s5
  s_and_b32 s49, s49, 3
  s_cmp_eq_u32 s49, 1
  s_mov_b32 s5, 0x10327654
  s_cselect_b32 s5, 0x32107654, s5
  s_cmp_eq_u32 s49, 2
  s_cselect_b32 s5, 0x54763210, s5
  s_cmp_eq_u32 s49, 3
  s_cselect_b32 s49, 0x76543210, s5
  s_mul_i32 s5, s50, 0x22222222
  s_add_u32 s5, s5, 0x10101010
  s_cmp_eq_u32 s15, 3
  s_cselect_b32 s49, s5, s49
  s_cselect_b32 s13, 0, s13
  s_lshl_b32 s14, s12, 2
  s_add_u32 s14, s14, s50
  v_lshlrev_b32 v3, 4, v2
  s_lshl_b32 s5, s13, 7
  s_add_u32 s52, s36, s5
  s_addc_u32 s53, s37, 0
  s_and_b32 s53, s53, 0xffff
  s_mov_b32 s54, 1831552
  s_mov_b32 s55, 0x00020000
  s_add_u32 s56, s38, s5
  s_addc_u32 s57, s39, 0
  s_sub_u32 s56, s56, 1024
  s_subb_u32 s57, s57, 0
  s_and_b32 s57, s57, 0xffff
  s_mov_b32 s58, 1832576
  s_mov_b32 s59, 0x00020000
  v_lshrrev_b32 v5, 3, v2
  v_mul_u32_u24 v5, 3584, v5
  v_bfe_u32 v6, v2, 4, 1
  v_lshlrev_b32 v6, 1, v6
  v_and_b32 v242, 7, v2
  v_xor_b32 v242, v242, v6
  v_xor_b32 v243, 4, v242
  v_lshl_add_u32 v242, v242, 4, v5
  v_lshl_add_u32 v243, v243, 4, v5
  v_add_u32 v243, 26624, v243
  s_lshl_b32 s18, s11, 13
  s_mul_i32 s19, s11, 114688
  v_bfe_u32 v5, v2, 2, 2
  v_lshrrev_b32 v6, 4, v2
  v_lshlrev_b32 v12, 11, v6
  v_lshl_add_u32 v12, v5, 7, v12
  v_lshrrev_b32 v5, 1, v5
  v_and_b32 v6, 1, v6
  v_lshl_add_u32 v5, v6, 1, v5
  v_xor_b32 v5, s11, v5
  v_lshl_add_u32 v12, v5, 5, v12
  v_and_b32 v5, 3, v2
  v_lshl_add_u32 v12, v5, 3, v12
  v_add_u32 v13, 65536, v12
  s_mov_b32 s21, 0x3f803f80
  s_add_u32 s5, s34, 0
  s_and_b32 s5, s5, 3
  s_mul_i32 s5, s5, 458752
  s_add_u32 s64, s5, s19
  s_add_u32 s65, s64, 57344
  s_add_u32 s5, s34, 1
  s_and_b32 s5, s5, 3
  s_mul_i32 s5, s5, 458752
  s_add_u32 s66, s5, s19
  s_add_u32 s67, s66, 57344
  s_add_u32 s5, s34, 2
  s_and_b32 s5, s5, 3
  s_mul_i32 s5, s5, 458752
  s_add_u32 s68, s5, s19
  s_add_u32 s69, s68, 57344
  s_add_u32 s5, s34, 3
  s_and_b32 s5, s5, 3
  s_mul_i32 s5, s5, 458752
  s_add_u32 s70, s5, s19
  s_add_u32 s71, s70, 57344
  v_lshrrev_b32 v5, 2, v2
  v_lshrrev_b32 v6, 4, v2
  v_xor_b32 v5, v5, v6
  v_mov_b32 v84, 0xbb00bb00
  v_mov_b32 v85, 0xbb00bb00
  v_mov_b32 v86, 0xbb00bb00
  v_mov_b32 v87, 0xbb00bb00
  v_and_b32 v6, 1, v2
  v_lshlrev_b32 v6, 4, v6
  v_mov_b32 v7, 0x3f80
  v_lshlrev_b32 v7, v6, v7
  v_and_b32 v5, 3, v5
  v_bfe_u32 v6, v2, 1, 1
  v_lshl_or_b32 v5, v5, 1, v6
  v_cmp_eq_u32 vcc, 0, v5
  v_mov_b32 v88, 0
  v_mov_b32 v89, 0
  v_cndmask_b32 v90, 0, v7, vcc
  v_cmp_eq_u32 vcc, 1, v5
  v_mov_b32 v92, 0
  v_mov_b32 v93, 0
  v_cndmask_b32 v91, 0, v7, vcc
  v_bfe_u32 v5, v0, 3, 1
  v_xor_b32 v5, v5, v0
  v_lshlrev_b32 v5, 4, v5
  v_add_u32 v240, 140800, v5
  v_lshrrev_b32 v6, 2, v0
  v_mul_u32_u24 v6, 32768, v6
  v_and_b32 v7, 3, v0
  v_lshl_add_u32 v6, v7, 4, v6
  s_lshl_b32 s5, s3, 7
  s_add_u32 s5, s5, 0x380000
  v_add_u32 v241, s5, v6
  s_lshl_b32 s22, s11, 12
  s_lshl_b32 s5, s3, 4
  s_add_u32 s22, s22, s5
  s_add_u32 s22, s22, 0x4000
  s_lshl_b32 s5, s11, 12
  v_add_u32 v5, s5, v3
  v_add_u32 v8, 140800, v5
  s_add_u32 s5, s5, 140800
  v_lshl_add_u32 v9, v2, 6, s5
  v_lshrrev_b32 v6, 1, v0
  v_mul_u32_u24 v6, 16384, v6
  v_and_b32 v7, 1, v0
  v_lshl_add_u32 v6, v7, 6, v6
  s_lshr_b32 s5, s3, 2
  s_lshl_b32 s5, s5, 8
  s_and_b32 s6, s3, 1
  s_lshl_b32 s6, s6, 7
  s_add_u32 s5, s5, s6
  s_and_b32 s6, s3, 2
  s_lshl_b32 s6, s6, 4
  s_add_u32 s5, s5, s6
  s_add_u32 s5, s5, 0x80000
  v_add_u32 v6, s5, v6
  v_lshlrev_b32 v15, 4, v0
  v_add_u32 v7, 132096, v15
  s_waitcnt lgkmcnt(0)
  s_mul_i32 s48, s48, 0x9e3779b1
  s_add_u32 s48, s48, 0x7f4a7c15
  s_lshl_b32 s72, s23, 16
  s_mov_b32 s73, s72
  s_and_b32 s74, s23, 0xffff0000
  s_mov_b32 s75, s74
  v_mov_b32 v79, s48
  s_waitcnt vmcnt(0)
  v_swap_b32 v17, v18
  v_swap_b32 v19, v22
  v_swap_b32 v18, v20
  v_swap_b32 v21, v22
  global_store_dwordx4 v24, v[16:19], s[46:47] offset:0 sc1
  global_store_dwordx4 v24, v[20:23], s[46:47] offset:128 sc1
  v_dot2_f32_bf16 v64, v16, s21, 0
  v_dot2_f32_bf16 v66, v16, v16, 0
  v_dot2_f32_bf16 v65, v17, s21, 0
  v_dot2_f32_bf16 v67, v17, v17, 0
  v_dot2_f32_bf16 v68, v18, s21, 0
  v_dot2_f32_bf16 v70, v18, v18, 0
  v_dot2_f32_bf16 v69, v19, s21, 0
  v_dot2_f32_bf16 v71, v19, v19, 0
  v_dot2_f32_bf16 v64, v20, s21, v64
  v_dot2_f32_bf16 v66, v20, v20, v66
  v_dot2_f32_bf16 v65, v21, s21, v65
  v_dot2_f32_bf16 v67, v21, v21, v67
  v_dot2_f32_bf16 v68, v22, s21, v68
  v_dot2_f32_bf16 v70, v22, v22, v70
  v_dot2_f32_bf16 v69, v23, s21, v69
  v_dot2_f32_bf16 v71, v23, v23, v71
  v_add_f32_dpp v64, v64, v64 row_ror:8 row_mask:0xf bank_mask:0x3
  v_add_f32_dpp v65, v65, v65 row_ror:8 row_mask:0xf bank_mask:0x3
  v_add_f32_dpp v66, v66, v66 row_ror:8 row_mask:0xf bank_mask:0x3
  v_add_f32_dpp v67, v67, v67 row_ror:8 row_mask:0xf bank_mask:0x3
  v_add_f32_dpp v64, v68, v68 row_ror:8 row_mask:0xf bank_mask:0xc
  v_add_f32_dpp v65, v69, v69 row_ror:8 row_mask:0xf bank_mask:0xc
  v_add_f32_dpp v66, v70, v70 row_ror:8 row_mask:0xf bank_mask:0xc
  v_add_f32_dpp v67, v71, v71 row_ror:8 row_mask:0xf bank_mask:0xc
  v_add_f32_dpp v64, v64, v64 row_half_mirror row_mask:0xf bank_mask:0x5
  v_add_f32_dpp v65, v65, v65 row_half_mirror row_mask:0xf bank_mask:0x5
  s_nop 0
  v_add_f32_dpp v64, v66, v66 row_half_mirror row_mask:0xf bank_mask:0xa
  v_add_f32_dpp v65, v67, v67 row_half_mirror row_mask:0xf bank_mask:0xa
  s_nop 1
  v_permlane16_swap_b32 v64, v65
  v_add_f32 v64, v64, v65
  s_nop 1
  v_add_f32_dpp v64, v64, v64 quad_perm:[1,0,3,2] row_mask:0xf bank_mask:0xf
  s_nop 1
  v_add_f32_dpp v64, v64, v64 quad_perm:[2,3,0,1] row_mask:0xf bank_mask:0xf
  s_mov_b32 exec_lo, 0x11111111
  s_mov_b32 exec_hi, 0x11111111
  ds_write_b32 v25, v64
  s_mov_b64 exec, 1
  ds_add_u32 v30, v31
  s_mov_b64 exec, -1
  s_mov_b32 s97, 0
lsp1:
  ds_read_b32 v4, v30 offset:0
  s_add_u32 s97, s97, 1
  s_waitcnt lgkmcnt(0)
  v_readfirstlane_b32 s96, v4
  s_cmp_ge_u32 s97, 4194304
  s_cbranch_scc1 lsx1
  s_cmp_lt_u32 s96, 4
  s_cbranch_scc1 lsp1
lsx1:
  ds_read_b128 v[48:51], v26 offset:0
  ds_read_b128 v[52:55], v26 offset:64
  ds_read_b128 v[56:59], v26 offset:128
  ds_read_b128 v[60:63], v26 offset:192
  s_waitcnt lgkmcnt(0)
  v_pk_add_f32 v[48:49], v[48:49], v[52:53]
  v_pk_add_f32 v[56:57], v[56:57], v[60:61]
  v_pk_add_f32 v[50:51], v[50:51], v[54:55]
  v_pk_add_f32 v[58:59], v[58:59], v[62:63]
  v_pk_add_f32 v[48:49], v[48:49], v[56:57]
  v_pk_add_f32 v[50:51], v[50:51], v[58:59]
  v_mul_f32 v68, 0x3b000000, v48
  v_mul_f32 v70, 0x3b000000, v49
  v_mul_f32 v69, 0x3b000000, v50
  v_mul_f32 v71, 0x3b000000, v51
  v_fma_f32 v69, -v68, v68, v69
  v_fma_f32 v71, -v70, v70, v71
  v_max_f32 v69, 0, v69
  v_max_f32 v71, 0, v71
  v_cvt_pk_bf16_f32 v68, v68, v69
  v_cvt_pk_bf16_f32 v70, v70, v71
  v_lshlrev_b32 v72, 16, v68
  v_lshlrev_b32 v73, 16, v70
  v_and_b32 v69, 0xffff0000, v68
  v_and_b32 v71, 0xffff0000, v70
  v_add_f32 v69, 0x3727c5ac, v69
  v_add_f32 v71, 0x3727c5ac, v71
  v_cvt_pk_bf16_f32 v69, v69, v69
  v_cvt_pk_bf16_f32 v71, v71, v71
  v_lshlrev_b32 v69, 16, v69
  v_lshlrev_b32 v71, 16, v71
  v_sqrt_f32 v69, v69
  v_sqrt_f32 v71, v71
  v_cvt_pk_bf16_f32 v69, v69, v69
  v_cvt_pk_bf16_f32 v71, v71, v71
  v_lshlrev_b32 v76, 16, v69
  v_lshlrev_b32 v77, 16, v71
  v_rcp_f32 v76, v76
  v_rcp_f32 v77, v77
  v_lshrrev_b32 v72, 16, v72
  v_or_b32 v78, v72, v73
  s_waitcnt vmcnt(0)
  s_mov_b64 exec, 1
  ds_add_rtn_u32 v4, v30, v31
  s_waitcnt lgkmcnt(0)
  v_readfirstlane_b32 s7, v4
  s_mov_b64 exec, 0xf
  s_cmp_lg_u32 s7, 7
  s_cbranch_scc1 x_nost
  global_store_dwordx4 v27, v[76:79], s[46:47] sc1
x_nost:
  s_mov_b64 exec, -1
  s_lshl_b32 s5, s34, 2
  s_add_u32 s5, s5, s11
  s_mul_i32 s5, s5, 114688
  s_lshl_b32 s8, s13, 7
  s_add_u32 s5, s5, s8
  v_and_b32 v253, 31, v0
  v_mul_u32_u24 v253, 3584, v253
  v_add_u32 v253, s5, v253
  s_mov_b32 exec_hi, 0
  s_bitcmp1_b32 s2, 2
  s_cselect_b32 s8, s38, s36
  s_cselect_b32 s9, s39, s37
  global_load_dword v253, v253, s[8:9]
  s_mov_b32 exec_hi, -1
  s_sleep 21
  s_mov_b64 s[98:99], exec
  s_mov_b32 s97, 0
poll2:
  global_load_dwordx4 v[112:115], v5, s[46:47] offset:0 sc1
  global_load_dwordx4 v[116:119], v5, s[46:47] offset:1024 sc1
  global_load_dwordx4 v[120:123], v5, s[46:47] offset:2048 sc1
  global_load_dwordx4 v[124:127], v5, s[46:47] offset:3072 sc1
  s_add_u32 s97, s97, 1
  s_waitcnt vmcnt(0)
  v_min3_u32 v4, v115, v119, v123
  v_max3_u32 v1, v115, v119, v123
  v_min3_u32 v4, v4, v127, s48
  v_max3_u32 v1, v1, v127, s48
  v_cmp_ne_u32 vcc, v4, v1
  s_nop 0
  s_and_b64 exec, exec, vcc
  s_cbranch_execz pollx2
  s_cmp_ge_u32 s97, 524288
  s_cbranch_scc1 pollx2
  s_sleep 1
  s_branch poll2
pollx2:
  s_mov_b64 exec, s[98:99]
  global_load_dwordx4 v[144:147], v6, s[46:47] sc1
  global_load_dwordx4 v[148:151], v6, s[46:47] offset:16 sc1
  ds_write_b128 v8, v[112:115] offset:0
  ds_write_b128 v8, v[116:119] offset:1024
  ds_write_b128 v8, v[120:123] offset:2048
  ds_write_b128 v8, v[124:127] offset:3072
  ds_read_b128 v[128:131], v9 offset:0
  ds_read_b128 v[132:135], v9 offset:16
  ds_read_b128 v[136:139], v9 offset:32
  ds_read_b128 v[140:143], v9 offset:48
  s_waitcnt lgkmcnt(0)
  v_lshlrev_b32 v192, 16, v130
  v_and_b32 v193, s4, v130
  v_lshlrev_b32 v194, 16, v134
  v_and_b32 v195, s4, v134
  v_lshlrev_b32 v196, 16, v138
  v_and_b32 v197, s4, v138
  v_lshlrev_b32 v198, 16, v142
  v_and_b32 v199, s4, v142
  v_pk_mul_f32 v[192:193], v[192:193], v[128:129] neg_lo:[1,0] neg_hi:[1,0]
  v_pk_mul_f32 v[194:195], v[194:195], v[132:133] neg_lo:[1,0] neg_hi:[1,0]
  v_pk_mul_f32 v[196:197], v[196:197], v[136:137] neg_lo:[1,0] neg_hi:[1,0]
  v_pk_mul_f32 v[198:199], v[198:199], v[140:141] neg_lo:[1,0] neg_hi:[1,0]
  s_mov_b32 s97, 0
lsp3:
  ds_read_b32 v4, v30 offset:4
  s_add_u32 s97, s97, 1
  s_waitcnt lgkmcnt(0)
  v_readfirstlane_b32 s96, v4
  s_cmp_ge_u32 s97, 4194304
  s_cbranch_scc1 lsx3
  s_cmp_lt_u32 s96, 4
  s_cbranch_scc1 lsp3
lsx3:
  s_cmp_lg_u32 s15, 3
  s_cbranch_scc1 h_ec
  s_waitcnt vmcnt(0)
  s_branch h_ecj
h_ec:
  s_add_u32 m0, s18, 0
  s_nop 0
  buffer_load_dwordx4 v242, s[52:55], s64 offen offset:0  lds
  buffer_load_dwordx4 v242, s[56:59], s64 offen offset:1024  lds
  buffer_load_dwordx4 v243, s[52:55], s64 offen offset:2048  lds
  buffer_load_dwordx4 v243, s[56:59], s64 offen offset:3072  lds
  s_waitcnt vmcnt(4)
h_ecj:
  v_lshlrev_b32 v224, 16, v144
  v_lshlrev_b32 v225, 16, v145
  v_lshlrev_b32 v226, 16, v146
  v_lshlrev_b32 v227, 16, v147
  v_lshlrev_b32 v228, 16, v148
  v_lshlrev_b32 v229, 16, v149
  v_lshlrev_b32 v230, 16, v150
  v_lshlrev_b32 v231, 16, v151
  v_pk_fma_f32 v[160:161], v[224:225], v[128:129], v[192:193]
  v_pk_fma_f32 v[162:163], v[226:227], v[132:133], v[194:195]
  v_pk_fma_f32 v[164:165], v[228:229], v[136:137], v[196:197]
  v_pk_fma_f32 v[166:167], v[230:231], v[140:141], v[198:199]
  v_cvt_pk_bf16_f32 v187, v161, v160
  v_cvt_pk_bf16_f32 v186, v163, v162
  v_cvt_pk_bf16_f32 v185, v165, v164
  v_cvt_pk_bf16_f32 v184, v167, v166
  ds_write_b128 v7, v[184:187] offset:0
  v_and_b32 v232, s4, v144
  v_and_b32 v233, s4, v145
  v_and_b32 v234, s4, v146
  v_and_b32 v235, s4, v147
  v_and_b32 v236, s4, v148
  v_and_b32 v237, s4, v149
  v_and_b32 v238, s4, v150
  v_and_b32 v239, s4, v151
  v_pk_fma_f32 v[168:169], v[232:233], v[128:129], v[192:193]
  v_pk_fma_f32 v[170:171], v[234:235], v[132:133], v[194:195]
  v_pk_fma_f32 v[172:173], v[236:237], v[136:137], v[196:197]
  v_pk_fma_f32 v[174:175], v[238:239], v[140:141], v[198:199]
  v_cvt_pk_bf16_f32 v191, v169, v168
  v_cvt_pk_bf16_f32 v190, v171, v170
  v_cvt_pk_bf16_f32 v189, v173, v172
  v_cvt_pk_bf16_f32 v188, v175, v174
  ds_write_b128 v7, v[188:191] offset:4608
  s_waitcnt lgkmcnt(0)
  s_barrier
  s_setprio 3
  s_cmp_eq_u32 s15, 3
  s_cbranch_scc1 h_spB
  s_add_u32 m0, s18, 4096
  s_nop 0
  buffer_load_dwordx4 v242, s[52:55], s65 offen offset:0  lds
  buffer_load_dwordx4 v242, s[56:59], s65 offen offset:1024  lds
  buffer_load_dwordx4 v243, s[52:55], s65 offen offset:2048  lds
  buffer_load_dwordx4 v243, s[56:59], s65 offen offset:3072  lds
  s_add_u32 m0, s18, 32768
  s_nop 0
  buffer_load_dwordx4 v242, s[52:55], s66 offen offset:0  lds
  buffer_load_dwordx4 v242, s[56:59], s66 offen offset:1024  lds
  buffer_load_dwordx4 v243, s[52:55], s66 offen offset:2048  lds
  buffer_load_dwordx4 v243, s[56:59], s66 offen offset:3072  lds
  s_add_u32 m0, s18, 36864
  s_nop 0
  buffer_load_dwordx4 v242, s[52:55], s67 offen offset:0  lds
  buffer_load_dwordx4 v242, s[56:59], s67 offen offset:1024  lds
  buffer_load_dwordx4 v243, s[52:55], s67 offen offset:2048  lds
  buffer_load_dwordx4 v243, s[56:59], s67 offen offset:3072  lds
  s_add_u32 m0, s18, 65536
  s_nop 0
  buffer_load_dwordx4 v242, s[52:55], s68 offen offset:0  lds
  buffer_load_dwordx4 v242, s[56:59], s68 offen offset:1024  lds
  buffer_load_dwordx4 v243, s[52:55], s68 offen offset:2048  lds
  buffer_load_dwordx4 v243, s[56:59], s68 offen offset:3072  lds
  s_add_u32 m0, s18, 69632
  s_nop 0
  buffer_load_dwordx4 v242, s[52:55], s69 offen offset:0  lds
  buffer_load_dwordx4 v242, s[56:59], s69 offen offset:1024  lds
  buffer_load_dwordx4 v243, s[52:55], s69 offen offset:2048  lds
  buffer_load_dwordx4 v243, s[56:59], s69 offen offset:3072  lds
  v_mov_b32 v250, 0
  s_mov_b32 exec_lo, 0x11111111
  s_mov_b32 exec_hi, 0x11111111
  global_store_dword v241, v250, s[46:47] offset:64 sc1
  s_mov_b64 exec, -1
  s_branch h_spJ
h_spB:
  v_mov_b32 v250, 0
  s_mov_b32 exec_lo, 0x11111111
  s_mov_b32 exec_hi, 0x11111111
  global_store_dword v241, v250, s[46:47] offset:64 sc1
  s_mov_b64 exec, -1
  s_lshl_b32 s5, s14, 2
  s_add_u32 s5, s5, s11
  s_mul_i32 s5, s5, 14336
  v_lshl_add_u32 v28, v2, 7, s5
  global_load_dword v252, v28, s[40:41]
  v_min_u32 v28, 47, v2
  s_add_u32 s5, s5, 8192
  v_lshl_add_u32 v28, v28, 7, s5
  global_load_dword v253, v28, s[40:41]
h_spJ:
  v_fmac_f32 v224, s72, v160
  v_fmac_f32 v225, s72, v161
  v_fmac_f32 v226, s72, v162
  v_fmac_f32 v227, s72, v163
  v_fmac_f32 v228, s72, v164
  v_fmac_f32 v229, s72, v165
  v_fmac_f32 v230, s72, v166
  v_fmac_f32 v231, s72, v167
  v_fmac_f32 v232, s74, v168
  v_fmac_f32 v233, s74, v169
  v_fmac_f32 v234, s74, v170
  v_fmac_f32 v235, s74, v171
  v_fmac_f32 v236, s74, v172
  v_fmac_f32 v237, s74, v173
  v_fmac_f32 v238, s74, v174
  v_fmac_f32 v239, s74, v175
  s_mov_b32 s8, 0x00003f80
  s_mov_b32 s9, 0x3f800000
  s_setprio 2
  s_barrier
  ds_read_b128 v[16:19], v240 offset:0
  ds_read_b128 v[20:23], v240 offset:4096
  ds_read_b128 v[24:27], v240 offset:8192
  ds_read_b128 v[28:31], v240 offset:12288
  s_waitcnt lgkmcnt(2)
  v_dot2_f32_bf16 v32, v16, s8, v224
  v_dot2_f32_bf16 v33, v16, s9, v225
  v_dot2_f32_bf16 v34, v17, s8, v226
  v_dot2_f32_bf16 v35, v17, s9, v227
  v_dot2_f32_bf16 v36, v18, s8, v228
  v_dot2_f32_bf16 v37, v18, s9, v229
  v_dot2_f32_bf16 v38, v19, s8, v230
  v_dot2_f32_bf16 v39, v19, s9, v231
  v_dot2_f32_bf16 v32, v20, s8, v32
  v_dot2_f32_bf16 v33, v20, s9, v33
  v_dot2_f32_bf16 v34, v21, s8, v34
  v_dot2_f32_bf16 v35, v21, s9, v35
  v_dot2_f32_bf16 v36, v22, s8, v36
  v_dot2_f32_bf16 v37, v22, s9, v37
  v_dot2_f32_bf16 v38, v23, s8, v38
  v_dot2_f32_bf16 v39, v23, s9, v39
  v_cvt_pk_bf16_f32 v48, v32, v33
  v_cvt_pk_bf16_f32 v49, v34, v35
  v_cvt_pk_bf16_f32 v50, v36, v37
  v_cvt_pk_bf16_f32 v51, v38, v39
  global_store_dwordx4 v241, v[48:51], s[46:47] offset:0 sc1
  s_waitcnt lgkmcnt(0)
  v_dot2_f32_bf16 v32, v24, s8, v232
  v_dot2_f32_bf16 v33, v24, s9, v233
  v_dot2_f32_bf16 v34, v25, s8, v234
  v_dot2_f32_bf16 v35, v25, s9, v235
  v_dot2_f32_bf16 v36, v26, s8, v236
  v_dot2_f32_bf16 v37, v26, s9, v237
  v_dot2_f32_bf16 v38, v27, s8, v238
  v_dot2_f32_bf16 v39, v27, s9, v239
  v_dot2_f32_bf16 v32, v28, s8, v32
  v_dot2_f32_bf16 v33, v28, s9, v33
  v_dot2_f32_bf16 v34, v29, s8, v34
  v_dot2_f32_bf16 v35, v29, s9, v35
  v_dot2_f32_bf16 v36, v30, s8, v36
  v_dot2_f32_bf16 v37, v30, s9, v37
  v_dot2_f32_bf16 v38, v31, s8, v38
  v_dot2_f32_bf16 v39, v31, s9, v39
  v_cvt_pk_bf16_f32 v52, v32, v33
  v_cvt_pk_bf16_f32 v53, v34, v35
  v_cvt_pk_bf16_f32 v54, v36, v37
  v_cvt_pk_bf16_f32 v55, v38, v39
  global_store_dwordx4 v241, v[52:55], s[46:47] offset:64 sc1
  s_cmp_eq_u32 s15, 3
  s_cbranch_scc1 h_spare
  s_waitcnt vmcnt(2)
  s_barrier
  s_add_u32 m0, s18, 98304
  s_nop 0
  buffer_load_dwordx4 v242, s[52:55], s70 offen offset:0  lds
  buffer_load_dwordx4 v242, s[56:59], s70 offen offset:1024  lds
  buffer_load_dwordx4 v243, s[52:55], s70 offen offset:2048  lds
  buffer_load_dwordx4 v243, s[56:59], s70 offen offset:3072  lds
  s_add_u32 m0, s18, 102400
  s_nop 0
  buffer_load_dwordx4 v242, s[52:55], s71 offen offset:0  lds
  buffer_load_dwordx4 v242, s[56:59], s71 offen offset:1024  lds
  buffer_load_dwordx4 v243, s[52:55], s71 offen offset:2048  lds
  buffer_load_dwordx4 v243, s[56:59], s71 offen offset:3072  lds
  ds_read_b64_tr_b16 v[96:97], v12 offset:0
  ds_read_b64_tr_b16 v[98:99], v12 offset:512
  ds_read_b64_tr_b16 v[100:101], v12 offset:1024
  ds_read_b64_tr_b16 v[102:103], v12 offset:1536
  ds_read_b64_tr_b16 v[104:105], v12 offset:8192
  ds_read_b64_tr_b16 v[106:107], v12 offset:8704
  ds_read_b64_tr_b16 v[108:109], v12 offset:9216
  ds_read_b64_tr_b16 v[110:111], v12 offset:9728
  ds_read_b64_tr_b16 v[112:113], v12 offset:16384
  ds_read_b64_tr_b16 v[114:115], v12 offset:16896
  ds_read_b64_tr_b16 v[116:117], v12 offset:17408
  ds_read_b64_tr_b16 v[118:119], v12 offset:17920
  ds_read_b64_tr_b16 v[120:121], v12 offset:24576
  ds_read_b64_tr_b16 v[122:123], v12 offset:25088
  ds_read_b64_tr_b16 v[124:125], v12 offset:25600
  ds_read_b64_tr_b16 v[126:127], v12 offset:26112
  ds_read_b64_tr_b16 v[128:129], v12 offset:32768
  ds_read_b64_tr_b16 v[130:131], v12 offset:33280
  ds_read_b64_tr_b16 v[132:133], v12 offset:33792
  ds_read_b64_tr_b16 v[134:135], v12 offset:34304
  ds_read_b64_tr_b16 v[136:137], v12 offset:40960
  ds_read_b64_tr_b16 v[138:139], v12 offset:41472
  ds_read_b64_tr_b16 v[140:141], v12 offset:41984
  ds_read_b64_tr_b16 v[142:143], v12 offset:42496
  ds_read_b64_tr_b16 v[144:145], v12 offset:49152
  ds_read_b64_tr_b16 v[146:147], v12 offset:49664
  ds_read_b64_tr_b16 v[148:149], v12 offset:50176
  ds_read_b64_tr_b16 v[150:151], v12 offset:50688
  ds_read_b64_tr_b16 v[152:153], v12 offset:57344
  ds_read_b64_tr_b16 v[154:155], v12 offset:57856
  ds_read_b64_tr_b16 v[156:157], v12 offset:58368
  ds_read_b64_tr_b16 v[158:159], v12 offset:58880
  s_waitcnt vmcnt(8)
  v_mov_b32 v8, s22
  v_mov_b32 v9, s48
  s_mov_b64 exec, 1
  global_store_dword v8, v9, s[46:47] sc1
  s_mov_b64 exec, -1
  s_waitcnt lgkmcnt(15)
  ds_read_b64_tr_b16 v[160:161], v13 offset:0
  ds_read_b64_tr_b16 v[162:163], v13 offset:512
  ds_read_b64_tr_b16 v[164:165], v13 offset:1024
  ds_read_b64_tr_b16 v[166:167], v13 offset:1536
  ds_read_b64_tr_b16 v[168:169], v13 offset:8192
  ds_read_b64_tr_b16 v[170:171], v13 offset:8704
  ds_read_b64_tr_b16 v[172:173], v13 offset:9216
  ds_read_b64_tr_b16 v[174:175], v13 offset:9728
  ds_read_b64_tr_b16 v[176:177], v13 offset:16384
  ds_read_b64_tr_b16 v[178:179], v13 offset:16896
  ds_read_b64_tr_b16 v[180:181], v13 offset:17408
  ds_read_b64_tr_b16 v[182:183], v13 offset:17920
  ds_read_b64_tr_b16 v[184:185], v13 offset:24576
  ds_read_b64_tr_b16 v[186:187], v13 offset:25088
  ds_read_b64_tr_b16 v[188:189], v13 offset:25600
  ds_read_b64_tr_b16 v[190:191], v13 offset:26112
  v_mfma_f32_16x16x32_bf16 v[76:79], v[84:87], v[96:99], 0
  v_mfma_f32_16x16x32_bf16 v[80:83], v[84:87], v[100:103], 0
  v_mfma_f32_16x16x32_bf16 v[76:79], v[84:87], v[104:107], v[76:79]
  v_mfma_f32_16x16x32_bf16 v[80:83], v[84:87], v[108:111], v[80:83]
  v_mfma_f32_16x16x32_bf16 v[76:79], v[84:87], v[112:115], v[76:79]
  v_mfma_f32_16x16x32_bf16 v[80:83], v[84:87], v[116:119], v[80:83]
  v_mfma_f32_16x16x32_bf16 v[76:79], v[84:87], v[120:123], v[76:79]
  v_mfma_f32_16x16x32_bf16 v[80:83], v[84:87], v[124:127], v[80:83]
  s_waitcnt lgkmcnt(0)
  v_mfma_f32_16x16x32_bf16 v[76:79], v[84:87], v[128:131], v[76:79]
  v_mfma_f32_16x16x32_bf16 v[80:83], v[84:87], v[132:135], v[80:83]
  v_mfma_f32_16x16x32_bf16 v[76:79], v[84:87], v[136:139], v[76:79]
  v_mfma_f32_16x16x32_bf16 v[80:83], v[84:87], v[140:143], v[80:83]
  v_mfma_f32_16x16x32_bf16 v[76:79], v[84:87], v[144:147], v[76:79]
  v_mfma_f32_16x16x32_bf16 v[80:83], v[84:87], v[148:151], v[80:83]
  v_mfma_f32_16x16x32_bf16 v[76:79], v[84:87], v[152:155], v[76:79]
  v_mfma_f32_16x16x32_bf16 v[80:83], v[84:87], v[156:159], v[80:83]
  v_mfma_f32_16x16x32_bf16 v[76:79], v[84:87], v[160:163], v[76:79]
  v_mfma_f32_16x16x32_bf16 v[80:83], v[84:87], v[164:167], v[80:83]
  v_mfma_f32_16x16x32_bf16 v[76:79], v[84:87], v[168:171], v[76:79]
  v_mfma_f32_16x16x32_bf16 v[80:83], v[84:87], v[172:175], v[80:83]
  v_mfma_f32_16x16x32_bf16 v[76:79], v[84:87], v[176:179], v[76:79]
  v_mfma_f32_16x16x32_bf16 v[80:83], v[84:87], v[180:183], v[80:83]
  v_mfma_f32_16x16x32_bf16 v[76:79], v[84:87], v[184:187], v[76:79]
  v_mfma_f32_16x16x32_bf16 v[80:83], v[84:87], v[188:191], v[80:83]
  s_waitcnt vmcnt(1)
  s_barrier
  ds_read_b64_tr_b16 v[192:193], v13 offset:32768
  ds_read_b64_tr_b16 v[194:195], v13 offset:33280
  ds_read_b64_tr_b16 v[196:197], v13 offset:33792
  ds_read_b64_tr_b16 v[198:199], v13 offset:34304
  ds_read_b64_tr_b16 v[200:201], v13 offset:40960
  ds_read_b64_tr_b16 v[202:203], v13 offset:41472
  ds_read_b64_tr_b16 v[204:205], v13 offset:41984
  ds_read_b64_tr_b16 v[206:207], v13 offset:42496
  ds_read_b64_tr_b16 v[208:209], v13 offset:49152
  ds_read_b64_tr_b16 v[210:211], v13 offset:49664
  ds_read_b64_tr_b16 v[212:213], v13 offset:50176
  ds_read_b64_tr_b16 v[214:215], v13 offset:50688
  ds_read_b64_tr_b16 v[216:217], v13 offset:57344
  ds_read_b64_tr_b16 v[218:219], v13 offset:57856
  ds_read_b64_tr_b16 v[220:221], v13 offset:58368
  ds_read_b64_tr_b16 v[222:223], v13 offset:58880
  v_bfe_u32 v6, v2, 2, 2
  v_lshrrev_b32 v8, 4, v2
  v_lshl_add_u32 v6, v8, 3, v6
  v_lshlrev_b32 v6, 6, v6
  v_and_b32 v7, 1, v8
  v_lshl_add_u32 v6, v7, 5, v6
  v_and_b32 v7, 3, v2
  v_lshl_add_u32 v12, v7, 3, v6
  v_add_u32 v13, 65536, v12
  v_xor_b32 v10, 32, v12
  v_xor_b32 v11, 32, v13
  s_waitcnt lgkmcnt(14)
  v_mfma_f32_16x16x32_bf16 v[76:79], v[84:87], v[192:195], v[76:79]
  s_waitcnt lgkmcnt(12)
  v_mfma_f32_16x16x32_bf16 v[80:83], v[84:87], v[196:199], v[80:83]
  s_waitcnt lgkmcnt(10)
  v_mfma_f32_16x16x32_bf16 v[76:79], v[84:87], v[200:203], v[76:79]
  s_waitcnt lgkmcnt(8)
  v_mfma_f32_16x16x32_bf16 v[80:83], v[84:87], v[204:207], v[80:83]
  s_waitcnt lgkmcnt(6)
  v_mfma_f32_16x16x32_bf16 v[76:79], v[84:87], v[208:211], v[76:79]
  s_waitcnt lgkmcnt(4)
  v_mfma_f32_16x16x32_bf16 v[80:83], v[84:87], v[212:215], v[80:83]
  s_waitcnt lgkmcnt(2)
  v_mfma_f32_16x16x32_bf16 v[76:79], v[84:87], v[216:219], v[76:79]
  s_waitcnt lgkmcnt(0)
  v_mfma_f32_16x16x32_bf16 v[80:83], v[84:87], v[220:223], v[80:83]
  s_nop 7
  v_mfma_f32_16x16x32_bf16 v[16:19], v[90:93], v[96:99], v[76:79]
  v_mfma_f32_16x16x32_bf16 v[20:23], v[88:91], v[96:99], v[76:79]
  s_lshl_b32 s5, s12, 2
  s_mul_i32 s5, s5, 112
  v_mfma_f32_16x16x32_bf16 v[24:27], v[90:93], v[100:103], v[80:83]
  v_mfma_f32_16x16x32_bf16 v[28:31], v[88:91], v[100:103], v[80:83]
  s_lshl_b32 s6, s13, 2
  s_add_u32 s5, s5, s6
  v_mfma_f32_16x16x32_bf16 v[32:35], v[90:93], v[128:131], v[76:79]
  v_cvt_pk_bf16_f32 v96, v16, v17
  v_cvt_pk_bf16_f32 v97, v18, v19
  v_mfma_f32_16x16x32_bf16 v[36:39], v[88:91], v[128:131], v[76:79]
  v_cvt_pk_bf16_f32 v98, v20, v21
  v_cvt_pk_bf16_f32 v99, v22, v23
  s_add_u32 s5, s5, s11
  s_lshl_b32 s5, s5, 11
  v_mfma_f32_16x16x32_bf16 v[40:43], v[90:93], v[132:135], v[80:83]
  v_cvt_pk_bf16_f32 v100, v24, v25
  v_cvt_pk_bf16_f32 v101, v26, v27
  v_mfma_f32_16x16x32_bf16 v[44:47], v[88:91], v[132:135], v[80:83]
  v_cvt_pk_bf16_f32 v102, v28, v29
  v_cvt_pk_bf16_f32 v103, v30, v31
  s_add_u32 s5, s5, 0x680000
  s_add_u32 s60, s46, s5
  v_mfma_f32_16x16x32_bf16 v[16:19], v[90:93], v[160:163], v[76:79]
  v_cvt_pk_bf16_f32 v128, v32, v33
  v_cvt_pk_bf16_f32 v129, v34, v35
  v_mfma_f32_16x16x32_bf16 v[20:23], v[88:91], v[160:163], v[76:79]
  v_cvt_pk_bf16_f32 v130, v36, v37
  v_cvt_pk_bf16_f32 v131, v38, v39
  s_addc_u32 s61, s47, 0
  s_and_b32 s61, s61, 0xffff
  v_mfma_f32_16x16x32_bf16 v[24:27], v[90:93], v[164:167], v[80:83]
  v_cvt_pk_bf16_f32 v132, v40, v41
  v_cvt_pk_bf16_f32 v133, v42, v43
  v_mfma_f32_16x16x32_bf16 v[28:31], v[88:91], v[164:167], v[80:83]
  v_cvt_pk_bf16_f32 v134, v44, v45
  v_cvt_pk_bf16_f32 v135, v46, v47
  s_mov_b32 s62, 0xe0000
  s_mov_b32 s63, 0x00020000
  v_mfma_f32_16x16x32_bf16 v[32:35], v[90:93], v[192:195], v[76:79]
  v_cvt_pk_bf16_f32 v160, v16, v17
  v_cvt_pk_bf16_f32 v161, v18, v19
  v_mfma_f32_16x16x32_bf16 v[36:39], v[88:91], v[192:195], v[76:79]
  v_cvt_pk_bf16_f32 v162, v20, v21
  v_cvt_pk_bf16_f32 v163, v22, v23
  s_mul_i32 s22, s12, 28
  s_add_u32 s22, s22, s13
  v_mfma_f32_16x16x32_bf16 v[40:43], v[90:93], v[196:199], v[80:83]
  v_cvt_pk_bf16_f32 v164, v24, v25
  v_cvt_pk_bf16_f32 v165, v26, v27
  v_mfma_f32_16x16x32_bf16 v[44:47], v[88:91], v[196:199], v[80:83]
  v_cvt_pk_bf16_f32 v166, v28, v29
  v_cvt_pk_bf16_f32 v167, v30, v31
  s_lshl_b32 s22, s22, 7
  s_add_u32 s22, s22, 0x20000
  v_mfma_f32_16x16x32_bf16 v[16:19], v[90:93], v[104:107], v[76:79]
  v_cvt_pk_bf16_f32 v192, v32, v33
  v_cvt_pk_bf16_f32 v193, v34, v35
  v_mfma_f32_16x16x32_bf16 v[20:23], v[88:91], v[104:107], v[76:79]
  v_cvt_pk_bf16_f32 v194, v36, v37
  v_cvt_pk_bf16_f32 v195, v38, v39
  v_mov_b32 v5, s22
  v_mov_b32 v6, s48
  v_mfma_f32_16x16x32_bf16 v[24:27], v[90:93], v[108:111], v[80:83]
  v_cvt_pk_bf16_f32 v196, v40, v41
  v_cvt_pk_bf16_f32 v197, v42, v43
  v_mfma_f32_16x16x32_bf16 v[28:31], v[88:91], v[108:111], v[80:83]
  v_cvt_pk_bf16_f32 v198, v44, v45
  v_cvt_pk_bf16_f32 v199, v46, v47
  v_mov_b32 v14, 32768
  s_lshl_b32 s5, s11, 2
  v_mfma_f32_16x16x32_bf16 v[32:35], v[90:93], v[136:139], v[76:79]
  v_cvt_pk_bf16_f32 v104, v16, v17
  v_cvt_pk_bf16_f32 v105, v18, v19
  v_mfma_f32_16x16x32_bf16 v[36:39], v[88:91], v[136:139], v[76:79]
  v_cvt_pk_bf16_f32 v106, v20, v21
  v_cvt_pk_bf16_f32 v107, v22, v23
  v_add_u32 v15, s5, v14
  s_bfe_u32 s7, s49, 0x20019
  v_mfma_f32_16x16x32_bf16 v[40:43], v[90:93], v[140:143], v[80:83]
  v_cvt_pk_bf16_f32 v108, v24, v25
  v_cvt_pk_bf16_f32 v109, v26, v27
  v_mfma_f32_16x16x32_bf16 v[44:47], v[88:91], v[140:143], v[80:83]
  v_cvt_pk_bf16_f32 v110, v28, v29
  v_cvt_pk_bf16_f32 v111, v30, v31
  s_mul_i32 s7, s7, 229376
  v_mfma_f32_16x16x32_bf16 v[16:19], v[90:93], v[168:171], v[76:79]
  v_cvt_pk_bf16_f32 v136, v32, v33
  v_cvt_pk_bf16_f32 v137, v34, v35
  v_mfma_f32_16x16x32_bf16 v[20:23], v[88:91], v[168:171], v[76:79]
  v_cvt_pk_bf16_f32 v138, v36, v37
  v_cvt_pk_bf16_f32 v139, v38, v39
  v_mfma_f32_16x16x32_bf16 v[24:27], v[90:93], v[172:175], v[80:83]
  v_cvt_pk_bf16_f32 v140, v40, v41
  v_cvt_pk_bf16_f32 v141, v42, v43
  v_mfma_f32_16x16x32_bf16 v[28:31], v[88:91], v[172:175], v[80:83]
  v_cvt_pk_bf16_f32 v142, v44, v45
  v_cvt_pk_bf16_f32 v143, v46, v47
  v_mfma_f32_16x16x32_bf16 v[32:35], v[90:93], v[200:203], v[76:79]
  v_cvt_pk_bf16_f32 v168, v16, v17
  v_cvt_pk_bf16_f32 v169, v18, v19
  v_mfma_f32_16x16x32_bf16 v[36:39], v[88:91], v[200:203], v[76:79]
  v_cvt_pk_bf16_f32 v170, v20, v21
  v_cvt_pk_bf16_f32 v171, v22, v23
  v_mfma_f32_16x16x32_bf16 v[40:43], v[90:93], v[204:207], v[80:83]
  v_cvt_pk_bf16_f32 v172, v24, v25
  v_cvt_pk_bf16_f32 v173, v26, v27
  v_mfma_f32_16x16x32_bf16 v[44:47], v[88:91], v[204:207], v[80:83]
  v_cvt_pk_bf16_f32 v174, v28, v29
  v_cvt_pk_bf16_f32 v175, v30, v31
  v_mfma_f32_16x16x32_bf16 v[16:19], v[90:93], v[112:115], v[76:79]
  v_cvt_pk_bf16_f32 v200, v32, v33
  v_cvt_pk_bf16_f32 v201, v34, v35
  v_mfma_f32_16x16x32_bf16 v[20:23], v[88:91], v[112:115], v[76:79]
  v_cvt_pk_bf16_f32 v202, v36, v37
  v_cvt_pk_bf16_f32 v203, v38, v39
  v_mfma_f32_16x16x32_bf16 v[24:27], v[90:93], v[116:119], v[80:83]
  v_cvt_pk_bf16_f32 v204, v40, v41
  v_cvt_pk_bf16_f32 v205, v42, v43
  v_mfma_f32_16x16x32_bf16 v[28:31], v[88:91], v[116:119], v[80:83]
  v_cvt_pk_bf16_f32 v206, v44, v45
  v_cvt_pk_bf16_f32 v207, v46, v47
  v_mfma_f32_16x16x32_bf16 v[32:35], v[90:93], v[144:147], v[76:79]
  v_cvt_pk_bf16_f32 v112, v16, v17
  v_cvt_pk_bf16_f32 v113, v18, v19
  v_mfma_f32_16x16x32_bf16 v[36:39], v[88:91], v[144:147], v[76:79]
  v_cvt_pk_bf16_f32 v114, v20, v21
  v_cvt_pk_bf16_f32 v115, v22, v23
  v_mfma_f32_16x16x32_bf16 v[40:43], v[90:93], v[148:151], v[80:83]
  v_cvt_pk_bf16_f32 v116, v24, v25
  v_cvt_pk_bf16_f32 v117, v26, v27
  v_mfma_f32_16x16x32_bf16 v[44:47], v[88:91], v[148:151], v[80:83]
  v_cvt_pk_bf16_f32 v118, v28, v29
  v_cvt_pk_bf16_f32 v119, v30, v31
  v_mfma_f32_16x16x32_bf16 v[16:19], v[90:93], v[176:179], v[76:79]
  v_cvt_pk_bf16_f32 v144, v32, v33
  v_cvt_pk_bf16_f32 v145, v34, v35
  v_mfma_f32_16x16x32_bf16 v[20:23], v[88:91], v[176:179], v[76:79]
  v_cvt_pk_bf16_f32 v146, v36, v37
  v_cvt_pk_bf16_f32 v147, v38, v39
  v_mfma_f32_16x16x32_bf16 v[24:27], v[90:93], v[180:183], v[80:83]
  v_cvt_pk_bf16_f32 v148, v40, v41
  v_cvt_pk_bf16_f32 v149, v42, v43
  v_mfma_f32_16x16x32_bf16 v[28:31], v[88:91], v[180:183], v[80:83]
  v_cvt_pk_bf16_f32 v150, v44, v45
  v_cvt_pk_bf16_f32 v151, v46, v47
  v_mfma_f32_16x16x32_bf16 v[32:35], v[90:93], v[208:211], v[76:79]
  v_cvt_pk_bf16_f32 v176, v16, v17
  v_cvt_pk_bf16_f32 v177, v18, v19
  v_mfma_f32_16x16x32_bf16 v[36:39], v[88:91], v[208:211], v[76:79]
  v_cvt_pk_bf16_f32 v178, v20, v21
  v_cvt_pk_bf16_f32 v179, v22, v23
  v_mfma_f32_16x16x32_bf16 v[40:43], v[90:93], v[212:215], v[80:83]
  v_cvt_pk_bf16_f32 v180, v24, v25
  v_cvt_pk_bf16_f32 v181, v26, v27
  v_mfma_f32_16x16x32_bf16 v[44:47], v[88:91], v[212:215], v[80:83]
  v_cvt_pk_bf16_f32 v182, v28, v29
  v_cvt_pk_bf16_f32 v183, v30, v31
  v_mfma_f32_16x16x32_bf16 v[16:19], v[90:93], v[120:123], v[76:79]
  v_cvt_pk_bf16_f32 v208, v32, v33
  v_cvt_pk_bf16_f32 v209, v34, v35
  v_mfma_f32_16x16x32_bf16 v[20:23], v[88:91], v[120:123], v[76:79]
  v_cvt_pk_bf16_f32 v210, v36, v37
  v_cvt_pk_bf16_f32 v211, v38, v39
  v_mfma_f32_16x16x32_bf16 v[24:27], v[90:93], v[124:127], v[80:83]
  v_cvt_pk_bf16_f32 v212, v40, v41
  v_cvt_pk_bf16_f32 v213, v42, v43
  v_mfma_f32_16x16x32_bf16 v[28:31], v[88:91], v[124:127], v[80:83]
  v_cvt_pk_bf16_f32 v214, v44, v45
  v_cvt_pk_bf16_f32 v215, v46, v47
  v_mfma_f32_16x16x32_bf16 v[32:35], v[90:93], v[152:155], v[76:79]
  v_cvt_pk_bf16_f32 v120, v16, v17
  v_cvt_pk_bf16_f32 v121, v18, v19
  v_mfma_f32_16x16x32_bf16 v[36:39], v[88:91], v[152:155], v[76:79]
  v_cvt_pk_bf16_f32 v122, v20, v21
  v_cvt_pk_bf16_f32 v123, v22, v23
  v_mfma_f32_16x16x32_bf16 v[40:43], v[90:93], v[156:159], v[80:83]
  v_cvt_pk_bf16_f32 v124, v24, v25
  v_cvt_pk_bf16_f32 v125, v26, v27
  v_mfma_f32_16x16x32_bf16 v[44:47], v[88:91], v[156:159], v[80:83]
  v_cvt_pk_bf16_f32 v126, v28, v29
  v_cvt_pk_bf16_f32 v127, v30, v31
  v_mfma_f32_16x16x32_bf16 v[16:19], v[90:93], v[184:187], v[76:79]
  v_cvt_pk_bf16_f32 v152, v32, v33
  v_cvt_pk_bf16_f32 v153, v34, v35
  v_mfma_f32_16x16x32_bf16 v[20:23], v[88:91], v[184:187], v[76:79]
  v_cvt_pk_bf16_f32 v154, v36, v37
  v_cvt_pk_bf16_f32 v155, v38, v39
  v_mfma_f32_16x16x32_bf16 v[24:27], v[90:93], v[188:191], v[80:83]
  v_cvt_pk_bf16_f32 v156, v40, v41
  v_cvt_pk_bf16_f32 v157, v42, v43
  v_mfma_f32_16x16x32_bf16 v[28:31], v[88:91], v[188:191], v[80:83]
  v_cvt_pk_bf16_f32 v158, v44, v45
  v_cvt_pk_bf16_f32 v159, v46, v47
  v_mfma_f32_16x16x32_bf16 v[32:35], v[90:93], v[216:219], v[76:79]
  v_cvt_pk_bf16_f32 v184, v16, v17
  v_cvt_pk_bf16_f32 v185, v18, v19
  v_mfma_f32_16x16x32_bf16 v[36:39], v[88:91], v[216:219], v[76:79]
  v_cvt_pk_bf16_f32 v186, v20, v21
  v_cvt_pk_bf16_f32 v187, v22, v23
  v_mfma_f32_16x16x32_bf16 v[40:43], v[90:93], v[220:223], v[80:83]
  v_cvt_pk_bf16_f32 v188, v24, v25
  v_cvt_pk_bf16_f32 v189, v26, v27
  v_mfma_f32_16x16x32_bf16 v[44:47], v[88:91], v[220:223], v[80:83]
  v_cvt_pk_bf16_f32 v190, v28, v29
  v_cvt_pk_bf16_f32 v191, v30, v31
  v_cvt_pk_bf16_f32 v216, v32, v33
  v_cvt_pk_bf16_f32 v217, v34, v35
  v_cvt_pk_bf16_f32 v218, v36, v37
  v_cvt_pk_bf16_f32 v219, v38, v39
  v_cvt_pk_bf16_f32 v220, v40, v41
  v_cvt_pk_bf16_f32 v221, v42, v43
  v_cvt_pk_bf16_f32 v222, v44, v45
  v_cvt_pk_bf16_f32 v223, v46, v47
  s_setprio 2
  s_barrier
  ds_read_b64_tr_b16 v[48:49], v12 offset:32768
  ds_read_b64_tr_b16 v[50:51], v12 offset:33024
  ds_read_b64_tr_b16 v[52:53], v10 offset:32768
  ds_read_b64_tr_b16 v[54:55], v10 offset:33024
  ds_read_b64_tr_b16 v[56:57], v12 offset:40960
  ds_read_b64_tr_b16 v[58:59], v12 offset:41216
  ds_read_b64_tr_b16 v[60:61], v10 offset:40960
  ds_read_b64_tr_b16 v[62:63], v10 offset:41216
  ds_read_b64_tr_b16 v[64:65], v12 offset:49152
  ds_read_b64_tr_b16 v[66:67], v12 offset:49408
  ds_read_b64_tr_b16 v[68:69], v10 offset:49152
  ds_read_b64_tr_b16 v[70:71], v10 offset:49408
  s_waitcnt lgkmcnt(8)
  v_mfma_f32_16x16x32_bf16 v[16:19], v[96:99], v[48:51], 0
  ds_read_b64_tr_b16 v[224:225], v12 offset:57344
  ds_read_b64_tr_b16 v[226:227], v12 offset:57600
  v_mfma_f32_16x16x32_bf16 v[24:27], v[100:103], v[48:51], 0
  ds_read_b64_tr_b16 v[228:229], v10 offset:57344
  ds_read_b64_tr_b16 v[230:231], v10 offset:57600
  v_mfma_f32_16x16x32_bf16 v[28:31], v[100:103], v[52:55], 0
  v_mfma_f32_16x16x32_bf16 v[20:23], v[96:99], v[52:55], 0
  s_waitcnt lgkmcnt(8)
  v_mfma_f32_16x16x32_bf16 v[16:19], v[128:131], v[56:59], v[16:19]
  v_mfma_f32_16x16x32_bf16 v[24:27], v[132:135], v[56:59], v[24:27]
  v_mfma_f32_16x16x32_bf16 v[28:31], v[132:135], v[60:63], v[28:31]
  v_mfma_f32_16x16x32_bf16 v[20:23], v[128:131], v[60:63], v[20:23]
  s_barrier
  s_waitcnt lgkmcnt(4)
  v_mfma_f32_16x16x32_bf16 v[16:19], v[160:163], v[64:67], v[16:19]
  ds_read_b64_tr_b16 v[232:233], v12 offset:34816
  ds_read_b64_tr_b16 v[234:235], v12 offset:35072
  v_mfma_f32_16x16x32_bf16 v[24:27], v[164:167], v[64:67], v[24:27]
  ds_read_b64_tr_b16 v[236:237], v10 offset:34816
  ds_read_b64_tr_b16 v[238:239], v10 offset:35072
  v_mfma_f32_16x16x32_bf16 v[28:31], v[164:167], v[68:71], v[28:31]
  ds_read_b64_tr_b16 v[48:49], v12 offset:43008
  ds_read_b64_tr_b16 v[50:51], v12 offset:43264
  v_mfma_f32_16x16x32_bf16 v[20:23], v[160:163], v[68:71], v[20:23]
  ds_read_b64_tr_b16 v[52:53], v10 offset:43008
  ds_read_b64_tr_b16 v[54:55], v10 offset:43264
  s_waitcnt lgkmcnt(8)
  v_mfma_f32_16x16x32_bf16 v[16:19], v[192:195], v[224:227], v[16:19]
  ds_read_b64_tr_b16 v[56:57], v12 offset:51200
  ds_read_b64_tr_b16 v[58:59], v12 offset:51456
  v_mfma_f32_16x16x32_bf16 v[24:27], v[196:199], v[224:227], v[24:27]
  ds_read_b64_tr_b16 v[60:61], v10 offset:51200
  ds_read_b64_tr_b16 v[62:63], v10 offset:51456
  v_mfma_f32_16x16x32_bf16 v[28:31], v[196:199], v[228:231], v[28:31]
  ds_read_b64_tr_b16 v[64:65], v12 offset:59392
  ds_read_b64_tr_b16 v[66:67], v12 offset:59648
  v_mfma_f32_16x16x32_bf16 v[20:23], v[192:195], v[228:231], v[20:23]
  ds_read_b64_tr_b16 v[68:69], v10 offset:59392
  s_waitcnt lgkmcnt(11)
  v_mfma_f32_16x16x32_bf16 v[16:19], v[104:107], v[232:235], v[16:19]
  ds_read_b64_tr_b16 v[70:71], v10 offset:59648
  v_mfma_f32_16x16x32_bf16 v[24:27], v[108:111], v[232:235], v[24:27]
  ds_read_b64_tr_b16 v[224:225], v12 offset:36864
  v_mfma_f32_16x16x32_bf16 v[28:31], v[108:111], v[236:239], v[28:31]
  ds_read_b64_tr_b16 v[226:227], v12 offset:37120
  v_mfma_f32_16x16x32_bf16 v[20:23], v[104:107], v[236:239], v[20:23]
  ds_read_b64_tr_b16 v[228:229], v10 offset:36864
  s_waitcnt lgkmcnt(11)
  v_mfma_f32_16x16x32_bf16 v[16:19], v[136:139], v[48:51], v[16:19]
  ds_read_b64_tr_b16 v[230:231], v10 offset:37120
  v_mfma_f32_16x16x32_bf16 v[24:27], v[140:143], v[48:51], v[24:27]
  ds_read_b64_tr_b16 v[232:233], v12 offset:45056
  v_mfma_f32_16x16x32_bf16 v[28:31], v[140:143], v[52:55], v[28:31]
  ds_read_b64_tr_b16 v[234:235], v12 offset:45312
  v_mfma_f32_16x16x32_bf16 v[20:23], v[136:139], v[52:55], v[20:23]
  ds_read_b64_tr_b16 v[236:237], v10 offset:45056
  s_waitcnt lgkmcnt(11)
  v_mfma_f32_16x16x32_bf16 v[16:19], v[168:171], v[56:59], v[16:19]
  ds_read_b64_tr_b16 v[238:239], v10 offset:45312
  v_mfma_f32_16x16x32_bf16 v[24:27], v[172:175], v[56:59], v[24:27]
  ds_read_b64_tr_b16 v[48:49], v12 offset:53248
  v_mfma_f32_16x16x32_bf16 v[28:31], v[172:175], v[60:63], v[28:31]
  ds_read_b64_tr_b16 v[50:51], v12 offset:53504
  v_mfma_f32_16x16x32_bf16 v[20:23], v[168:171], v[60:63], v[20:23]
  ds_read_b64_tr_b16 v[52:53], v10 offset:53248
  s_waitcnt lgkmcnt(11)
  v_mfma_f32_16x16x32_bf16 v[16:19], v[200:203], v[64:67], v[16:19]
  ds_read_b64_tr_b16 v[54:55], v10 offset:53504
  v_mfma_f32_16x16x32_bf16 v[24:27], v[204:207], v[64:67], v[24:27]
  ds_read_b64_tr_b16 v[56:57], v12 offset:61440
  v_mfma_f32_16x16x32_bf16 v[28:31], v[204:207], v[68:71], v[28:31]
  ds_read_b64_tr_b16 v[58:59], v12 offset:61696
  v_mfma_f32_16x16x32_bf16 v[20:23], v[200:203], v[68:71], v[20:23]
  ds_read_b64_tr_b16 v[60:61], v10 offset:61440
  s_waitcnt lgkmcnt(11)
  v_mfma_f32_16x16x32_bf16 v[16:19], v[112:115], v[224:227], v[16:19]
  ds_read_b64_tr_b16 v[62:63], v10 offset:61696
  v_mfma_f32_16x16x32_bf16 v[24:27], v[116:119], v[224:227], v[24:27]
  ds_read_b64_tr_b16 v[64:65], v12 offset:38912
  v_mfma_f32_16x16x32_bf16 v[28:31], v[116:119], v[228:231], v[28:31]
  ds_read_b64_tr_b16 v[66:67], v12 offset:39168
  v_mfma_f32_16x16x32_bf16 v[20:23], v[112:115], v[228:231], v[20:23]
  ds_read_b64_tr_b16 v[68:69], v10 offset:38912
  s_waitcnt lgkmcnt(11)
  v_mfma_f32_16x16x32_bf16 v[16:19], v[144:147], v[232:235], v[16:19]
  ds_read_b64_tr_b16 v[70:71], v10 offset:39168
  v_mfma_f32_16x16x32_bf16 v[24:27], v[148:151], v[232:235], v[24:27]
  ds_read_b64_tr_b16 v[224:225], v12 offset:47104
  v_mfma_f32_16x16x32_bf16 v[28:31], v[148:151], v[236:239], v[28:31]
  ds_read_b64_tr_b16 v[226:227], v12 offset:47360
  v_mfma_f32_16x16x32_bf16 v[20:23], v[144:147], v[236:239], v[20:23]
  ds_read_b64_tr_b16 v[228:229], v10 offset:47104
  s_waitcnt lgkmcnt(11)
  v_mfma_f32_16x16x32_bf16 v[16:19], v[176:179], v[48:51], v[16:19]
  ds_read_b64_tr_b16 v[230:231], v10 offset:47360
  v_mfma_f32_16x16x32_bf16 v[24:27], v[180:183], v[48:51], v[24:27]
  ds_read_b64_tr_b16 v[232:233], v12 offset:55296
  v_mfma_f32_16x16x32_bf16 v[28:31], v[180:183], v[52:55], v[28:31]
  ds_read_b64_tr_b16 v[234:235], v12 offset:55552
  v_mfma_f32_16x16x32_bf16 v[20:23], v[176:179], v[52:55], v[20:23]
  ds_read_b64_tr_b16 v[236:237], v10 offset:55296
  s_waitcnt lgkmcnt(11)
  v_mfma_f32_16x16x32_bf16 v[16:19], v[208:211], v[56:59], v[16:19]
  ds_read_b64_tr_b16 v[238:239], v10 offset:55552
  v_mfma_f32_16x16x32_bf16 v[24:27], v[212:215], v[56:59], v[24:27]
  ds_read_b64_tr_b16 v[48:49], v12 offset:63488
  v_mfma_f32_16x16x32_bf16 v[28:31], v[212:215], v[60:63], v[28:31]
  ds_read_b64_tr_b16 v[50:51], v12 offset:63744
  v_mfma_f32_16x16x32_bf16 v[20:23], v[208:211], v[60:63], v[20:23]
  ds_read_b64_tr_b16 v[52:53], v10 offset:63488
  s_waitcnt lgkmcnt(11)
  v_mfma_f32_16x16x32_bf16 v[16:19], v[120:123], v[64:67], v[16:19]
  ds_read_b64_tr_b16 v[54:55], v10 offset:63744
  v_mfma_f32_16x16x32_bf16 v[24:27], v[124:127], v[64:67], v[24:27]
  v_mfma_f32_16x16x32_bf16 v[28:31], v[124:127], v[68:71], v[28:31]
  v_mfma_f32_16x16x32_bf16 v[20:23], v[120:123], v[68:71], v[20:23]
  s_waitcnt lgkmcnt(8)
  v_mfma_f32_16x16x32_bf16 v[16:19], v[152:155], v[224:227], v[16:19]
  v_mfma_f32_16x16x32_bf16 v[24:27], v[156:159], v[224:227], v[24:27]
  v_mfma_f32_16x16x32_bf16 v[28:31], v[156:159], v[228:231], v[28:31]
  v_mfma_f32_16x16x32_bf16 v[20:23], v[152:155], v[228:231], v[20:23]
  s_waitcnt lgkmcnt(0)
  s_barrier
  s_waitcnt lgkmcnt(4)
  v_mfma_f32_16x16x32_bf16 v[16:19], v[184:187], v[232:235], v[16:19]
  ds_read_b64_tr_b16 v[56:57], v13 offset:0
  ds_read_b64_tr_b16 v[58:59], v13 offset:256
  v_mfma_f32_16x16x32_bf16 v[24:27], v[188:191], v[232:235], v[24:27]
  ds_read_b64_tr_b16 v[60:61], v11 offset:0
  ds_read_b64_tr_b16 v[62:63], v11 offset:256
  v_mfma_f32_16x16x32_bf16 v[28:31], v[188:191], v[236:239], v[28:31]
  ds_read_b64_tr_b16 v[64:65], v13 offset:8192
  ds_read_b64_tr_b16 v[66:67], v13 offset:8448
  v_mfma_f32_16x16x32_bf16 v[20:23], v[184:187], v[236:239], v[20:23]
  ds_read_b64_tr_b16 v[68:69], v11 offset:8192
  ds_read_b64_tr_b16 v[70:71], v11 offset:8448
  s_waitcnt lgkmcnt(8)
  v_mfma_f32_16x16x32_bf16 v[16:19], v[216:219], v[48:51], v[16:19]
  ds_read_b64_tr_b16 v[224:225], v13 offset:16384
  ds_read_b64_tr_b16 v[226:227], v13 offset:16640
  v_mfma_f32_16x16x32_bf16 v[24:27], v[220:223], v[48:51], v[24:27]
  ds_read_b64_tr_b16 v[228:229], v11 offset:16384
  ds_read_b64_tr_b16 v[230:231], v11 offset:16640
  v_mfma_f32_16x16x32_bf16 v[28:31], v[220:223], v[52:55], v[28:31]
  ds_read_b64_tr_b16 v[232:233], v13 offset:24576
  ds_read_b64_tr_b16 v[234:235], v13 offset:24832
  v_mfma_f32_16x16x32_bf16 v[20:23], v[216:219], v[52:55], v[20:23]
  ds_read_b64_tr_b16 v[236:237], v11 offset:24576
  s_waitcnt lgkmcnt(11)
  v_mfma_f32_16x16x32_bf16 v[32:35], v[96:99], v[56:59], 0
  ds_read_b64_tr_b16 v[238:239], v11 offset:24832
  v_mfma_f32_16x16x32_bf16 v[40:43], v[100:103], v[56:59], 0
  ds_read_b64_tr_b16 v[48:49], v13 offset:2048
  v_mfma_f32_16x16x32_bf16 v[44:47], v[100:103], v[60:63], 0
  ds_read_b64_tr_b16 v[50:51], v13 offset:2304
  v_mfma_f32_16x16x32_bf16 v[36:39], v[96:99], v[60:63], 0
  ds_read_b64_tr_b16 v[52:53], v11 offset:2048
  s_waitcnt lgkmcnt(11)
  v_mfma_f32_16x16x32_bf16 v[32:35], v[128:131], v[64:67], v[32:35]
  ds_read_b64_tr_b16 v[54:55], v11 offset:2304
  v_mul_f32 v16, v16, v24
  v_mfma_f32_16x16x32_bf16 v[40:43], v[132:135], v[64:67], v[40:43]
  ds_read_b64_tr_b16 v[56:57], v13 offset:10240
  v_mul_f32 v17, v17, v25
  v_mfma_f32_16x16x32_bf16 v[44:47], v[132:135], v[68:71], v[44:47]
  ds_read_b64_tr_b16 v[58:59], v13 offset:10496
  v_mfma_f32_16x16x32_bf16 v[36:39], v[128:131], v[68:71], v[36:39]
  ds_read_b64_tr_b16 v[60:61], v11 offset:10240
  s_waitcnt lgkmcnt(11)
  v_mfma_f32_16x16x32_bf16 v[32:35], v[160:163], v[224:227], v[32:35]
  ds_read_b64_tr_b16 v[62:63], v11 offset:10496
  v_mul_f32 v18, v18, v26
  v_mfma_f32_16x16x32_bf16 v[40:43], v[164:167], v[224:227], v[40:43]
  ds_read_b64_tr_b16 v[64:65], v13 offset:18432
  v_mul_f32 v19, v19, v27
  v_mfma_f32_16x16x32_bf16 v[44:47], v[164:167], v[228:231], v[44:47]
  ds_read_b64_tr_b16 v[66:67], v13 offset:18688
  v_mfma_f32_16x16x32_bf16 v[36:39], v[160:163], v[228:231], v[36:39]
  ds_read_b64_tr_b16 v[68:69], v11 offset:18432
  s_waitcnt lgkmcnt(11)
  v_mfma_f32_16x16x32_bf16 v[32:35], v[192:195], v[232:235], v[32:35]
  ds_read_b64_tr_b16 v[70:71], v11 offset:18688
  v_mul_f32 v20, v20, v28
  v_mfma_f32_16x16x32_bf16 v[40:43], v[196:199], v[232:235], v[40:43]
  ds_read_b64_tr_b16 v[224:225], v13 offset:26624
  v_mul_f32 v21, v21, v29
  v_mfma_f32_16x16x32_bf16 v[44:47], v[196:199], v[236:239], v[44:47]
  ds_read_b64_tr_b16 v[226:227], v13 offset:26880
  v_mfma_f32_16x16x32_bf16 v[36:39], v[192:195], v[236:239], v[36:39]
  ds_read_b64_tr_b16 v[228:229], v11 offset:26624
  s_waitcnt lgkmcnt(11)
  v_mfma_f32_16x16x32_bf16 v[32:35], v[104:107], v[48:51], v[32:35]
  ds_read_b64_tr_b16 v[230:231], v11 offset:26880
  v_mul_f32 v22, v22, v30
  v_mfma_f32_16x16x32_bf16 v[40:43], v[108:111], v[48:51], v[40:43]
  ds_read_b64_tr_b16 v[232:233], v13 offset:4096
  v_mul_f32 v23, v23, v31
  v_mfma_f32_16x16x32_bf16 v[44:47], v[108:111], v[52:55], v[44:47]
  ds_read_b64_tr_b16 v[234:235], v13 offset:4352
  v_mfma_f32_16x16x32_bf16 v[36:39], v[104:107], v[52:55], v[36:39]
  ds_read_b64_tr_b16 v[236:237], v11 offset:4096
  s_waitcnt lgkmcnt(11)
  v_mfma_f32_16x16x32_bf16 v[32:35], v[136:139], v[56:59], v[32:35]
  ds_read_b64_tr_b16 v[238:239], v11 offset:4352
  v_cvt_pk_bf16_f32 v80, v16, v17
  v_mfma_f32_16x16x32_bf16 v[40:43], v[140:143], v[56:59], v[40:43]
  ds_read_b64_tr_b16 v[48:49], v13 offset:12288
  v_cvt_pk_bf16_f32 v81, v18, v19
  v_mfma_f32_16x16x32_bf16 v[44:47], v[140:143], v[60:63], v[44:47]
  ds_read_b64_tr_b16 v[50:51], v13 offset:12544
  v_mfma_f32_16x16x32_bf16 v[36:39], v[136:139], v[60:63], v[36:39]
  ds_read_b64_tr_b16 v[52:53], v11 offset:12288
  s_waitcnt lgkmcnt(11)
  v_mfma_f32_16x16x32_bf16 v[32:35], v[168:171], v[64:67], v[32:35]
  ds_read_b64_tr_b16 v[54:55], v11 offset:12544
  v_cvt_pk_bf16_f32 v82, v20, v21
  v_mfma_f32_16x16x32_bf16 v[40:43], v[172:175], v[64:67], v[40:43]
  ds_read_b64_tr_b16 v[56:57], v13 offset:20480
  v_cvt_pk_bf16_f32 v83, v22, v23
  v_mfma_f32_16x16x32_bf16 v[44:47], v[172:175], v[68:71], v[44:47]
  ds_read_b64_tr_b16 v[58:59], v13 offset:20736
  v_mfma_f32_16x16x32_bf16 v[36:39], v[168:171], v[68:71], v[36:39]
  ds_read_b64_tr_b16 v[60:61], v11 offset:20480
  s_waitcnt lgkmcnt(11)
  v_mfma_f32_16x16x32_bf16 v[32:35], v[200:203], v[224:227], v[32:35]
  ds_read_b64_tr_b16 v[62:63], v11 offset:20736
  v_permlane16_swap_b32 v80, v82
  v_mfma_f32_16x16x32_bf16 v[40:43], v[204:207], v[224:227], v[40:43]
  ds_read_b64_tr_b16 v[64:65], v13 offset:28672
  v_permlane16_swap_b32 v81, v83
  v_mfma_f32_16x16x32_bf16 v[44:47], v[204:207], v[228:231], v[44:47]
  ds_read_b64_tr_b16 v[66:67], v13 offset:28928
  v_mfma_f32_16x16x32_bf16 v[36:39], v[200:203], v[228:231], v[36:39]
  ds_read_b64_tr_b16 v[68:69], v11 offset:28672
  s_waitcnt lgkmcnt(11)
  v_mfma_f32_16x16x32_bf16 v[32:35], v[112:115], v[232:235], v[32:35]
  ds_read_b64_tr_b16 v[70:71], v11 offset:28928
  s_bfe_u32 s5, s49, 0x20001
  v_mfma_f32_16x16x32_bf16 v[40:43], v[116:119], v[232:235], v[40:43]
  ds_read_b64_tr_b16 v[224:225], v13 offset:6144
  s_mul_i32 s5, s5, 229376
  v_mfma_f32_16x16x32_bf16 v[44:47], v[116:119], v[236:239], v[44:47]
  ds_read_b64_tr_b16 v[226:227], v13 offset:6400
  v_mfma_f32_16x16x32_bf16 v[36:39], v[112:115], v[236:239], v[36:39]
  ds_read_b64_tr_b16 v[228:229], v11 offset:6144
  s_waitcnt lgkmcnt(11)
  v_mfma_f32_16x16x32_bf16 v[32:35], v[144:147], v[48:51], v[32:35]
  ds_read_b64_tr_b16 v[230:231], v11 offset:6400
  s_lshr_b32 s49, s49, 8
  v_mfma_f32_16x16x32_bf16 v[40:43], v[148:151], v[48:51], v[40:43]
  ds_read_b64_tr_b16 v[232:233], v13 offset:14336
  v_mfma_f32_16x16x32_bf16 v[44:47], v[148:151], v[52:55], v[44:47]
  ds_read_b64_tr_b16 v[234:235], v13 offset:14592
  v_mfma_f32_16x16x32_bf16 v[36:39], v[144:147], v[52:55], v[36:39]
  ds_read_b64_tr_b16 v[236:237], v11 offset:14336
  s_waitcnt lgkmcnt(11)
  v_mfma_f32_16x16x32_bf16 v[32:35], v[176:179], v[56:59], v[32:35]
  ds_read_b64_tr_b16 v[238:239], v11 offset:14592
  v_mfma_f32_16x16x32_bf16 v[40:43], v[180:183], v[56:59], v[40:43]
  ds_read_b64_tr_b16 v[48:49], v13 offset:22528
  v_mfma_f32_16x16x32_bf16 v[44:47], v[180:183], v[60:63], v[44:47]
  ds_read_b64_tr_b16 v[50:51], v13 offset:22784
  v_mfma_f32_16x16x32_bf16 v[36:39], v[176:179], v[60:63], v[36:39]
  ds_read_b64_tr_b16 v[52:53], v11 offset:22528
  s_waitcnt lgkmcnt(11)
  v_mfma_f32_16x16x32_bf16 v[32:35], v[208:211], v[64:67], v[32:35]
  ds_read_b64_tr_b16 v[54:55], v11 offset:22784
  v_mfma_f32_16x16x32_bf16 v[40:43], v[212:215], v[64:67], v[40:43]
  ds_read_b64_tr_b16 v[56:57], v13 offset:30720
  v_mfma_f32_16x16x32_bf16 v[44:47], v[212:215], v[68:71], v[44:47]
  ds_read_b64_tr_b16 v[58:59], v13 offset:30976
  v_mfma_f32_16x16x32_bf16 v[36:39], v[208:211], v[68:71], v[36:39]
  ds_read_b64_tr_b16 v[60:61], v11 offset:30720
  s_waitcnt lgkmcnt(11)
  v_mfma_f32_16x16x32_bf16 v[32:35], v[120:123], v[224:227], v[32:35]
  ds_read_b64_tr_b16 v[62:63], v11 offset:30976
  v_mfma_f32_16x16x32_bf16 v[40:43], v[124:127], v[224:227], v[40:43]
  v_mfma_f32_16x16x32_bf16 v[44:47], v[124:127], v[228:231], v[44:47]
  v_mfma_f32_16x16x32_bf16 v[36:39], v[120:123], v[228:231], v[36:39]
  s_waitcnt lgkmcnt(8)
  v_mfma_f32_16x16x32_bf16 v[32:35], v[152:155], v[232:235], v[32:35]
  v_mfma_f32_16x16x32_bf16 v[40:43], v[156:159], v[232:235], v[40:43]
  v_mfma_f32_16x16x32_bf16 v[44:47], v[156:159], v[236:239], v[44:47]
  v_mfma_f32_16x16x32_bf16 v[36:39], v[152:155], v[236:239], v[36:39]
  s_waitcnt lgkmcnt(0)
  s_barrier
  s_waitcnt lgkmcnt(4)
  v_mfma_f32_16x16x32_bf16 v[32:35], v[184:187], v[48:51], v[32:35]
  ds_read_b64_tr_b16 v[64:65], v12 offset:0
  ds_read_b64_tr_b16 v[66:67], v12 offset:256
  v_mfma_f32_16x16x32_bf16 v[40:43], v[188:191], v[48:51], v[40:43]
  ds_read_b64_tr_b16 v[68:69], v10 offset:0
  ds_read_b64_tr_b16 v[70:71], v10 offset:256
  v_mfma_f32_16x16x32_bf16 v[44:47], v[188:191], v[52:55], v[44:47]
  ds_read_b64_tr_b16 v[224:225], v12 offset:8192
  ds_read_b64_tr_b16 v[226:227], v12 offset:8448
  v_mfma_f32_16x16x32_bf16 v[36:39], v[184:187], v[52:55], v[36:39]
  ds_read_b64_tr_b16 v[228:229], v10 offset:8192
  ds_read_b64_tr_b16 v[230:231], v10 offset:8448
  s_waitcnt lgkmcnt(8)
  v_mfma_f32_16x16x32_bf16 v[32:35], v[216:219], v[56:59], v[32:35]
  ds_read_b64_tr_b16 v[232:233], v12 offset:16384
  ds_read_b64_tr_b16 v[234:235], v12 offset:16640
  v_mfma_f32_16x16x32_bf16 v[40:43], v[220:223], v[56:59], v[40:43]
  ds_read_b64_tr_b16 v[236:237], v10 offset:16384
  ds_read_b64_tr_b16 v[238:239], v10 offset:16640
  v_mfma_f32_16x16x32_bf16 v[44:47], v[220:223], v[60:63], v[44:47]
  ds_read_b64_tr_b16 v[48:49], v12 offset:24576
  ds_read_b64_tr_b16 v[50:51], v12 offset:24832
  v_mfma_f32_16x16x32_bf16 v[36:39], v[216:219], v[60:63], v[36:39]
  ds_read_b64_tr_b16 v[52:53], v10 offset:24576
  s_waitcnt lgkmcnt(11)
  v_mfma_f32_16x16x32_bf16 v[16:19], v[96:99], v[64:67], 0
  ds_read_b64_tr_b16 v[54:55], v10 offset:24832
  v_mfma_f32_16x16x32_bf16 v[24:27], v[100:103], v[64:67], 0
  ds_read_b64_tr_b16 v[56:57], v12 offset:2048
  v_mfma_f32_16x16x32_bf16 v[28:31], v[100:103], v[68:71], 0
  ds_read_b64_tr_b16 v[58:59], v12 offset:2304
  v_mfma_f32_16x16x32_bf16 v[20:23], v[96:99], v[68:71], 0
  ds_read_b64_tr_b16 v[60:61], v10 offset:2048
  s_waitcnt lgkmcnt(11)
  v_mfma_f32_16x16x32_bf16 v[16:19], v[128:131], v[224:227], v[16:19]
  ds_read_b64_tr_b16 v[62:63], v10 offset:2304
  v_mul_f32 v32, v32, v40
  v_mfma_f32_16x16x32_bf16 v[24:27], v[132:135], v[224:227], v[24:27]
  ds_read_b64_tr_b16 v[64:65], v12 offset:10240
  v_mul_f32 v33, v33, v41
  v_mfma_f32_16x16x32_bf16 v[28:31], v[132:135], v[228:231], v[28:31]
  ds_read_b64_tr_b16 v[66:67], v12 offset:10496
  v_mfma_f32_16x16x32_bf16 v[20:23], v[128:131], v[228:231], v[20:23]
  ds_read_b64_tr_b16 v[68:69], v10 offset:10240
  s_waitcnt lgkmcnt(11)
  v_mfma_f32_16x16x32_bf16 v[16:19], v[160:163], v[232:235], v[16:19]
  ds_read_b64_tr_b16 v[70:71], v10 offset:10496
  v_mul_f32 v34, v34, v42
  v_mfma_f32_16x16x32_bf16 v[24:27], v[164:167], v[232:235], v[24:27]
  ds_read_b64_tr_b16 v[224:225], v12 offset:18432
  v_mul_f32 v35, v35, v43
  v_mfma_f32_16x16x32_bf16 v[28:31], v[164:167], v[236:239], v[28:31]
  ds_read_b64_tr_b16 v[226:227], v12 offset:18688
  v_mfma_f32_16x16x32_bf16 v[20:23], v[160:163], v[236:239], v[20:23]
  ds_read_b64_tr_b16 v[228:229], v10 offset:18432
  s_waitcnt lgkmcnt(11)
  v_mfma_f32_16x16x32_bf16 v[16:19], v[192:195], v[48:51], v[16:19]
  ds_read_b64_tr_b16 v[230:231], v10 offset:18688
  v_mul_f32 v36, v36, v44
  v_mfma_f32_16x16x32_bf16 v[24:27], v[196:199], v[48:51], v[24:27]
  ds_read_b64_tr_b16 v[232:233], v12 offset:26624
  v_mul_f32 v37, v37, v45
  v_mfma_f32_16x16x32_bf16 v[28:31], v[196:199], v[52:55], v[28:31]
  ds_read_b64_tr_b16 v[234:235], v12 offset:26880
  v_mfma_f32_16x16x32_bf16 v[20:23], v[192:195], v[52:55], v[20:23]
  ds_read_b64_tr_b16 v[236:237], v10 offset:26624
  s_waitcnt lgkmcnt(11)
  v_mfma_f32_16x16x32_bf16 v[16:19], v[104:107], v[56:59], v[16:19]
  ds_read_b64_tr_b16 v[238:239], v10 offset:26880
  v_mul_f32 v38, v38, v46
  v_mfma_f32_16x16x32_bf16 v[24:27], v[108:111], v[56:59], v[24:27]
  ds_read_b64_tr_b16 v[48:49], v12 offset:4096
  v_mul_f32 v39, v39, v47
  v_mfma_f32_16x16x32_bf16 v[28:31], v[108:111], v[60:63], v[28:31]
  ds_read_b64_tr_b16 v[50:51], v12 offset:4352
  v_mfma_f32_16x16x32_bf16 v[20:23], v[104:107], v[60:63], v[20:23]
  ds_read_b64_tr_b16 v[52:53], v10 offset:4096
  s_waitcnt lgkmcnt(11)
  v_mfma_f32_16x16x32_bf16 v[16:19], v[136:139], v[64:67], v[16:19]
  ds_read_b64_tr_b16 v[54:55], v10 offset:4352
  v_cvt_pk_bf16_f32 v84, v32, v33
  v_mfma_f32_16x16x32_bf16 v[24:27], v[140:143], v[64:67], v[24:27]
  ds_read_b64_tr_b16 v[56:57], v12 offset:12288
  v_cvt_pk_bf16_f32 v85, v34, v35
  v_mfma_f32_16x16x32_bf16 v[28:31], v[140:143], v[68:71], v[28:31]
  ds_read_b64_tr_b16 v[58:59], v12 offset:12544
  v_mfma_f32_16x16x32_bf16 v[20:23], v[136:139], v[68:71], v[20:23]
  ds_read_b64_tr_b16 v[60:61], v10 offset:12288
  s_waitcnt lgkmcnt(11)
  v_mfma_f32_16x16x32_bf16 v[16:19], v[168:171], v[224:227], v[16:19]
  ds_read_b64_tr_b16 v[62:63], v10 offset:12544
  v_cvt_pk_bf16_f32 v86, v36, v37
  v_mfma_f32_16x16x32_bf16 v[24:27], v[172:175], v[224:227], v[24:27]
  ds_read_b64_tr_b16 v[64:65], v12 offset:20480
  v_cvt_pk_bf16_f32 v87, v38, v39
  v_mfma_f32_16x16x32_bf16 v[28:31], v[172:175], v[228:231], v[28:31]
  ds_read_b64_tr_b16 v[66:67], v12 offset:20736
  v_mfma_f32_16x16x32_bf16 v[20:23], v[168:171], v[228:231], v[20:23]
  ds_read_b64_tr_b16 v[68:69], v10 offset:20480
  s_waitcnt lgkmcnt(11)
  v_mfma_f32_16x16x32_bf16 v[16:19], v[200:203], v[232:235], v[16:19]
  ds_read_b64_tr_b16 v[70:71], v10 offset:20736
  v_permlane16_swap_b32 v84, v86
  v_mfma_f32_16x16x32_bf16 v[24:27], v[204:207], v[232:235], v[24:27]
  ds_read_b64_tr_b16 v[224:225], v12 offset:28672
  v_permlane16_swap_b32 v85, v87
  v_mfma_f32_16x16x32_bf16 v[28:31], v[204:207], v[236:239], v[28:31]
  ds_read_b64_tr_b16 v[226:227], v12 offset:28928
  v_mfma_f32_16x16x32_bf16 v[20:23], v[200:203], v[236:239], v[20:23]
  ds_read_b64_tr_b16 v[228:229], v10 offset:28672
  s_waitcnt lgkmcnt(11)
  v_mfma_f32_16x16x32_bf16 v[16:19], v[112:115], v[48:51], v[16:19]
  ds_read_b64_tr_b16 v[230:231], v10 offset:28928
  buffer_store_dwordx4 v[80:83], v3, s[60:63], s5 offen sc1
  v_mfma_f32_16x16x32_bf16 v[24:27], v[116:119], v[48:51], v[24:27]
  ds_read_b64_tr_b16 v[232:233], v12 offset:6144
  buffer_store_dwordx4 v[84:87], v3, s[60:63], s5 offen offset:1024 sc1
  v_mfma_f32_16x16x32_bf16 v[28:31], v[116:119], v[52:55], v[28:31]
  ds_read_b64_tr_b16 v[234:235], v12 offset:6400
  v_mfma_f32_16x16x32_bf16 v[20:23], v[112:115], v[52:55], v[20:23]
  ds_read_b64_tr_b16 v[236:237], v10 offset:6144
  s_waitcnt lgkmcnt(11)
  v_mfma_f32_16x16x32_bf16 v[16:19], v[144:147], v[56:59], v[16:19]
  ds_read_b64_tr_b16 v[238:239], v10 offset:6400
  v_mfma_f32_16x16x32_bf16 v[24:27], v[148:151], v[56:59], v[24:27]
  ds_read_b64_tr_b16 v[48:49], v12 offset:14336
  v_mfma_f32_16x16x32_bf16 v[28:31], v[148:151], v[60:63], v[28:31]
  ds_read_b64_tr_b16 v[50:51], v12 offset:14592
  v_mfma_f32_16x16x32_bf16 v[20:23], v[144:147], v[60:63], v[20:23]
  ds_read_b64_tr_b16 v[52:53], v10 offset:14336
  s_waitcnt lgkmcnt(11)
  v_mfma_f32_16x16x32_bf16 v[16:19], v[176:179], v[64:67], v[16:19]
  ds_read_b64_tr_b16 v[54:55], v10 offset:14592
  v_mfma_f32_16x16x32_bf16 v[24:27], v[180:183], v[64:67], v[24:27]
  ds_read_b64_tr_b16 v[56:57], v12 offset:22528
  v_mfma_f32_16x16x32_bf16 v[28:31], v[180:183], v[68:71], v[28:31]
  ds_read_b64_tr_b16 v[58:59], v12 offset:22784
  v_mfma_f32_16x16x32_bf16 v[20:23], v[176:179], v[68:71], v[20:23]
  ds_read_b64_tr_b16 v[60:61], v10 offset:22528
  s_waitcnt lgkmcnt(11)
  v_mfma_f32_16x16x32_bf16 v[16:19], v[208:211], v[224:227], v[16:19]
  ds_read_b64_tr_b16 v[62:63], v10 offset:22784
  v_mfma_f32_16x16x32_bf16 v[24:27], v[212:215], v[224:227], v[24:27]
  ds_read_b64_tr_b16 v[64:65], v12 offset:30720
  v_mfma_f32_16x16x32_bf16 v[28:31], v[212:215], v[228:231], v[28:31]
  ds_read_b64_tr_b16 v[66:67], v12 offset:30976
  v_mfma_f32_16x16x32_bf16 v[20:23], v[208:211], v[228:231], v[20:23]
  ds_read_b64_tr_b16 v[68:69], v10 offset:30720
  s_waitcnt lgkmcnt(11)
  v_mfma_f32_16x16x32_bf16 v[16:19], v[120:123], v[232:235], v[16:19]
  ds_read_b64_tr_b16 v[70:71], v10 offset:30976
  v_mfma_f32_16x16x32_bf16 v[24:27], v[124:127], v[232:235], v[24:27]
  v_mfma_f32_16x16x32_bf16 v[28:31], v[124:127], v[236:239], v[28:31]
  v_mfma_f32_16x16x32_bf16 v[20:23], v[120:123], v[236:239], v[20:23]
  s_waitcnt lgkmcnt(8)
  v_mfma_f32_16x16x32_bf16 v[16:19], v[152:155], v[48:51], v[16:19]
  v_mfma_f32_16x16x32_bf16 v[24:27], v[156:159], v[48:51], v[24:27]
  v_mfma_f32_16x16x32_bf16 v[28:31], v[156:159], v[52:55], v[28:31]
  v_mfma_f32_16x16x32_bf16 v[20:23], v[152:155], v[52:55], v[20:23]
  s_waitcnt lgkmcnt(0)
  s_barrier
  s_waitcnt lgkmcnt(4)
  v_mfma_f32_16x16x32_bf16 v[16:19], v[184:187], v[56:59], v[16:19]
  ds_read_b64_tr_b16 v[224:225], v12 offset:32768
  ds_read_b64_tr_b16 v[226:227], v12 offset:33024
  v_mfma_f32_16x16x32_bf16 v[24:27], v[188:191], v[56:59], v[24:27]
  ds_read_b64_tr_b16 v[228:229], v10 offset:32768
  ds_read_b64_tr_b16 v[230:231], v10 offset:33024
  v_mfma_f32_16x16x32_bf16 v[28:31], v[188:191], v[60:63], v[28:31]
  ds_read_b64_tr_b16 v[232:233], v12 offset:40960
  ds_read_b64_tr_b16 v[234:235], v12 offset:41216
  v_mfma_f32_16x16x32_bf16 v[20:23], v[184:187], v[60:63], v[20:23]
  ds_read_b64_tr_b16 v[236:237], v10 offset:40960
  ds_read_b64_tr_b16 v[238:239], v10 offset:41216
  s_waitcnt lgkmcnt(8)
  v_mfma_f32_16x16x32_bf16 v[16:19], v[216:219], v[64:67], v[16:19]
  ds_read_b64_tr_b16 v[48:49], v12 offset:49152
  ds_read_b64_tr_b16 v[50:51], v12 offset:49408
  v_mfma_f32_16x16x32_bf16 v[24:27], v[220:223], v[64:67], v[24:27]
  ds_read_b64_tr_b16 v[52:53], v10 offset:49152
  ds_read_b64_tr_b16 v[54:55], v10 offset:49408
  v_mfma_f32_16x16x32_bf16 v[28:31], v[220:223], v[68:71], v[28:31]
  ds_read_b64_tr_b16 v[56:57], v12 offset:57344
  ds_read_b64_tr_b16 v[58:59], v12 offset:57600
  v_mfma_f32_16x16x32_bf16 v[20:23], v[216:219], v[68:71], v[20:23]
  ds_read_b64_tr_b16 v[60:61], v10 offset:57344
  s_waitcnt lgkmcnt(11)
  v_mfma_f32_16x16x32_bf16 v[32:35], v[96:99], v[224:227], 0
  ds_read_b64_tr_b16 v[62:63], v10 offset:57600
  v_mfma_f32_16x16x32_bf16 v[40:43], v[100:103], v[224:227], 0
  ds_read_b64_tr_b16 v[64:65], v12 offset:34816
  v_mfma_f32_16x16x32_bf16 v[44:47], v[100:103], v[228:231], 0
  ds_read_b64_tr_b16 v[66:67], v12 offset:35072
  v_mfma_f32_16x16x32_bf16 v[36:39], v[96:99], v[228:231], 0
  ds_read_b64_tr_b16 v[68:69], v10 offset:34816
  s_waitcnt lgkmcnt(11)
  v_mfma_f32_16x16x32_bf16 v[32:35], v[128:131], v[232:235], v[32:35]
  ds_read_b64_tr_b16 v[70:71], v10 offset:35072
  v_mul_f32 v16, v16, v24
  v_mfma_f32_16x16x32_bf16 v[40:43], v[132:135], v[232:235], v[40:43]
  ds_read_b64_tr_b16 v[224:225], v12 offset:43008
  v_mul_f32 v17, v17, v25
  v_mfma_f32_16x16x32_bf16 v[44:47], v[132:135], v[236:239], v[44:47]
  ds_read_b64_tr_b16 v[226:227], v12 offset:43264
  v_mfma_f32_16x16x32_bf16 v[36:39], v[128:131], v[236:239], v[36:39]
  ds_read_b64_tr_b16 v[228:229], v10 offset:43008
  s_waitcnt lgkmcnt(11)
  v_mfma_f32_16x16x32_bf16 v[32:35], v[160:163], v[48:51], v[32:35]
  ds_read_b64_tr_b16 v[230:231], v10 offset:43264
  v_mul_f32 v18, v18, v26
  v_mfma_f32_16x16x32_bf16 v[40:43], v[164:167], v[48:51], v[40:43]
  ds_read_b64_tr_b16 v[232:233], v12 offset:51200
  v_mul_f32 v19, v19, v27
  v_mfma_f32_16x16x32_bf16 v[44:47], v[164:167], v[52:55], v[44:47]
  ds_read_b64_tr_b16 v[234:235], v12 offset:51456
  v_mfma_f32_16x16x32_bf16 v[36:39], v[160:163], v[52:55], v[36:39]
  ds_read_b64_tr_b16 v[236:237], v10 offset:51200
  s_waitcnt lgkmcnt(11)
  v_mfma_f32_16x16x32_bf16 v[32:35], v[192:195], v[56:59], v[32:35]
  ds_read_b64_tr_b16 v[238:239], v10 offset:51456
  v_mul_f32 v20, v20, v28
  v_mfma_f32_16x16x32_bf16 v[40:43], v[196:199], v[56:59], v[40:43]
  ds_read_b64_tr_b16 v[48:49], v12 offset:59392
  v_mul_f32 v21, v21, v29
  v_mfma_f32_16x16x32_bf16 v[44:47], v[196:199], v[60:63], v[44:47]
  ds_read_b64_tr_b16 v[50:51], v12 offset:59648
  v_mfma_f32_16x16x32_bf16 v[36:39], v[192:195], v[60:63], v[36:39]
  ds_read_b64_tr_b16 v[52:53], v10 offset:59392
  s_waitcnt lgkmcnt(11)
  v_mfma_f32_16x16x32_bf16 v[32:35], v[104:107], v[64:67], v[32:35]
  ds_read_b64_tr_b16 v[54:55], v10 offset:59648
  v_mul_f32 v22, v22, v30
  v_mfma_f32_16x16x32_bf16 v[40:43], v[108:111], v[64:67], v[40:43]
  ds_read_b64_tr_b16 v[56:57], v12 offset:36864
  v_mul_f32 v23, v23, v31
  v_mfma_f32_16x16x32_bf16 v[44:47], v[108:111], v[68:71], v[44:47]
  ds_read_b64_tr_b16 v[58:59], v12 offset:37120
  v_mfma_f32_16x16x32_bf16 v[36:39], v[104:107], v[68:71], v[36:39]
  ds_read_b64_tr_b16 v[60:61], v10 offset:36864
  s_waitcnt lgkmcnt(11)
  v_mfma_f32_16x16x32_bf16 v[32:35], v[136:139], v[224:227], v[32:35]
  ds_read_b64_tr_b16 v[62:63], v10 offset:37120
  v_cvt_pk_bf16_f32 v80, v16, v17
  v_mfma_f32_16x16x32_bf16 v[40:43], v[140:143], v[224:227], v[40:43]
  ds_read_b64_tr_b16 v[64:65], v12 offset:45056
  v_cvt_pk_bf16_f32 v81, v18, v19
  v_mfma_f32_16x16x32_bf16 v[44:47], v[140:143], v[228:231], v[44:47]
  ds_read_b64_tr_b16 v[66:67], v12 offset:45312
  v_mfma_f32_16x16x32_bf16 v[36:39], v[136:139], v[228:231], v[36:39]
  ds_read_b64_tr_b16 v[68:69], v10 offset:45056
  s_waitcnt lgkmcnt(11)
  v_mfma_f32_16x16x32_bf16 v[32:35], v[168:171], v[232:235], v[32:35]
  ds_read_b64_tr_b16 v[70:71], v10 offset:45312
  v_cvt_pk_bf16_f32 v82, v20, v21
  v_mfma_f32_16x16x32_bf16 v[40:43], v[172:175], v[232:235], v[40:43]
  ds_read_b64_tr_b16 v[224:225], v12 offset:53248
  v_cvt_pk_bf16_f32 v83, v22, v23
  v_mfma_f32_16x16x32_bf16 v[44:47], v[172:175], v[236:239], v[44:47]
  ds_read_b64_tr_b16 v[226:227], v12 offset:53504
  v_mfma_f32_16x16x32_bf16 v[36:39], v[168:171], v[236:239], v[36:39]
  ds_read_b64_tr_b16 v[228:229], v10 offset:53248
  s_waitcnt lgkmcnt(11)
  v_mfma_f32_16x16x32_bf16 v[32:35], v[200:203], v[48:51], v[32:35]
  ds_read_b64_tr_b16 v[230:231], v10 offset:53504
  v_permlane16_swap_b32 v80, v82
  v_mfma_f32_16x16x32_bf16 v[40:43], v[204:207], v[48:51], v[40:43]
  ds_read_b64_tr_b16 v[232:233], v12 offset:61440
  v_permlane16_swap_b32 v81, v83
  v_mfma_f32_16x16x32_bf16 v[44:47], v[204:207], v[52:55], v[44:47]
  ds_read_b64_tr_b16 v[234:235], v12 offset:61696
  v_mfma_f32_16x16x32_bf16 v[36:39], v[200:203], v[52:55], v[36:39]
  ds_read_b64_tr_b16 v[236:237], v10 offset:61440
  s_waitcnt lgkmcnt(11)
  v_mfma_f32_16x16x32_bf16 v[32:35], v[112:115], v[56:59], v[32:35]
  ds_read_b64_tr_b16 v[238:239], v10 offset:61696
  s_bfe_u32 s5, s49, 0x20001
  v_mfma_f32_16x16x32_bf16 v[40:43], v[116:119], v[56:59], v[40:43]
  ds_read_b64_tr_b16 v[48:49], v12 offset:38912
  s_mul_i32 s5, s5, 229376
  v_mfma_f32_16x16x32_bf16 v[44:47], v[116:119], v[60:63], v[44:47]
  ds_read_b64_tr_b16 v[50:51], v12 offset:39168
  v_mfma_f32_16x16x32_bf16 v[36:39], v[112:115], v[60:63], v[36:39]
  ds_read_b64_tr_b16 v[52:53], v10 offset:38912
  s_waitcnt lgkmcnt(11)
  v_mfma_f32_16x16x32_bf16 v[32:35], v[144:147], v[64:67], v[32:35]
  ds_read_b64_tr_b16 v[54:55], v10 offset:39168
  s_lshr_b32 s49, s49, 8
  v_mfma_f32_16x16x32_bf16 v[40:43], v[148:151], v[64:67], v[40:43]
  ds_read_b64_tr_b16 v[56:57], v12 offset:47104
  v_mfma_f32_16x16x32_bf16 v[44:47], v[148:151], v[68:71], v[44:47]
  ds_read_b64_tr_b16 v[58:59], v12 offset:47360
  v_mfma_f32_16x16x32_bf16 v[36:39], v[144:147], v[68:71], v[36:39]
  ds_read_b64_tr_b16 v[60:61], v10 offset:47104
  s_waitcnt lgkmcnt(11)
  v_mfma_f32_16x16x32_bf16 v[32:35], v[176:179], v[224:227], v[32:35]
  ds_read_b64_tr_b16 v[62:63], v10 offset:47360
  v_mfma_f32_16x16x32_bf16 v[40:43], v[180:183], v[224:227], v[40:43]
  ds_read_b64_tr_b16 v[64:65], v12 offset:55296
  v_mfma_f32_16x16x32_bf16 v[44:47], v[180:183], v[228:231], v[44:47]
  ds_read_b64_tr_b16 v[66:67], v12 offset:55552
  v_mfma_f32_16x16x32_bf16 v[36:39], v[176:179], v[228:231], v[36:39]
  ds_read_b64_tr_b16 v[68:69], v10 offset:55296
  s_waitcnt lgkmcnt(11)
  v_mfma_f32_16x16x32_bf16 v[32:35], v[208:211], v[232:235], v[32:35]
  ds_read_b64_tr_b16 v[70:71], v10 offset:55552
  v_mfma_f32_16x16x32_bf16 v[40:43], v[212:215], v[232:235], v[40:43]
  ds_read_b64_tr_b16 v[224:225], v12 offset:63488
  v_mfma_f32_16x16x32_bf16 v[44:47], v[212:215], v[236:239], v[44:47]
  ds_read_b64_tr_b16 v[226:227], v12 offset:63744
  v_mfma_f32_16x16x32_bf16 v[36:39], v[208:211], v[236:239], v[36:39]
  ds_read_b64_tr_b16 v[228:229], v10 offset:63488
  s_waitcnt lgkmcnt(11)
  v_mfma_f32_16x16x32_bf16 v[32:35], v[120:123], v[48:51], v[32:35]
  ds_read_b64_tr_b16 v[230:231], v10 offset:63744
  v_mfma_f32_16x16x32_bf16 v[40:43], v[124:127], v[48:51], v[40:43]
  v_mfma_f32_16x16x32_bf16 v[44:47], v[124:127], v[52:55], v[44:47]
  v_mfma_f32_16x16x32_bf16 v[36:39], v[120:123], v[52:55], v[36:39]
  s_waitcnt lgkmcnt(8)
  v_mfma_f32_16x16x32_bf16 v[32:35], v[152:155], v[56:59], v[32:35]
  v_mfma_f32_16x16x32_bf16 v[40:43], v[156:159], v[56:59], v[40:43]
  v_mfma_f32_16x16x32_bf16 v[44:47], v[156:159], v[60:63], v[44:47]
  v_mfma_f32_16x16x32_bf16 v[36:39], v[152:155], v[60:63], v[36:39]
  s_waitcnt vmcnt(0) lgkmcnt(0)
  s_barrier
  s_waitcnt lgkmcnt(4)
  v_mfma_f32_16x16x32_bf16 v[32:35], v[184:187], v[64:67], v[32:35]
  ds_read_b64_tr_b16 v[232:233], v13 offset:0
  ds_read_b64_tr_b16 v[234:235], v13 offset:256
  v_mfma_f32_16x16x32_bf16 v[40:43], v[188:191], v[64:67], v[40:43]
  ds_read_b64_tr_b16 v[236:237], v11 offset:0
  ds_read_b64_tr_b16 v[238:239], v11 offset:256
  v_mfma_f32_16x16x32_bf16 v[44:47], v[188:191], v[68:71], v[44:47]
  ds_read_b64_tr_b16 v[48:49], v13 offset:8192
  ds_read_b64_tr_b16 v[50:51], v13 offset:8448
  v_mfma_f32_16x16x32_bf16 v[36:39], v[184:187], v[68:71], v[36:39]
  ds_read_b64_tr_b16 v[52:53], v11 offset:8192
  ds_read_b64_tr_b16 v[54:55], v11 offset:8448
  s_cmp_lg_u32 s11, 0
  s_cbranch_scc1 hf4
  s_mov_b64 exec, 1
  global_store_dword v5, v6, s[46:47] sc1
  s_mov_b64 exec, -1
hf4:
  v_add_u32 v5, 0x8000, v5
  s_waitcnt lgkmcnt(8)
  v_mfma_f32_16x16x32_bf16 v[32:35], v[216:219], v[224:227], v[32:35]
  ds_read_b64_tr_b16 v[56:57], v13 offset:16384
  ds_read_b64_tr_b16 v[58:59], v13 offset:16640
  v_mfma_f32_16x16x32_bf16 v[40:43], v[220:223], v[224:227], v[40:43]
  ds_read_b64_tr_b16 v[60:61], v11 offset:16384
  ds_read_b64_tr_b16 v[62:63], v11 offset:16640
  v_mfma_f32_16x16x32_bf16 v[44:47], v[220:223], v[228:231], v[44:47]
  ds_read_b64_tr_b16 v[64:65], v13 offset:24576
  ds_read_b64_tr_b16 v[66:67], v13 offset:24832
  v_mfma_f32_16x16x32_bf16 v[36:39], v[216:219], v[228:231], v[36:39]
  ds_read_b64_tr_b16 v[68:69], v11 offset:24576
  s_waitcnt lgkmcnt(11)
  v_mfma_f32_16x16x32_bf16 v[16:19], v[96:99], v[232:235], 0
  ds_read_b64_tr_b16 v[70:71], v11 offset:24832
  v_mfma_f32_16x16x32_bf16 v[24:27], v[100:103], v[232:235], 0
  ds_read_b64_tr_b16 v[224:225], v13 offset:2048
  v_mfma_f32_16x16x32_bf16 v[28:31], v[100:103], v[236:239], 0
  ds_read_b64_tr_b16 v[226:227], v13 offset:2304
  v_mfma_f32_16x16x32_bf16 v[20:23], v[96:99], v[236:239], 0
  ds_read_b64_tr_b16 v[228:229], v11 offset:2048
  s_waitcnt lgkmcnt(11)
  v_mfma_f32_16x16x32_bf16 v[16:19], v[128:131], v[48:51], v[16:19]
  ds_read_b64_tr_b16 v[230:231], v11 offset:2304
  v_mul_f32 v32, v32, v40
  v_mfma_f32_16x16x32_bf16 v[24:27], v[132:135], v[48:51], v[24:27]
  ds_read_b64_tr_b16 v[232:233], v13 offset:10240
  v_mul_f32 v33, v33, v41
  v_mfma_f32_16x16x32_bf16 v[28:31], v[132:135], v[52:55], v[28:31]
  ds_read_b64_tr_b16 v[234:235], v13 offset:10496
  v_mfma_f32_16x16x32_bf16 v[20:23], v[128:131], v[52:55], v[20:23]
  ds_read_b64_tr_b16 v[236:237], v11 offset:10240
  s_waitcnt lgkmcnt(11)
  v_mfma_f32_16x16x32_bf16 v[16:19], v[160:163], v[56:59], v[16:19]
  ds_read_b64_tr_b16 v[238:239], v11 offset:10496
  v_mul_f32 v34, v34, v42
  v_mfma_f32_16x16x32_bf16 v[24:27], v[164:167], v[56:59], v[24:27]
  ds_read_b64_tr_b16 v[48:49], v13 offset:18432
  v_mul_f32 v35, v35, v43
  v_mfma_f32_16x16x32_bf16 v[28:31], v[164:167], v[60:63], v[28:31]
  ds_read_b64_tr_b16 v[50:51], v13 offset:18688
  v_mfma_f32_16x16x32_bf16 v[20:23], v[160:163], v[60:63], v[20:23]
  ds_read_b64_tr_b16 v[52:53], v11 offset:18432
  s_waitcnt lgkmcnt(11)
  v_mfma_f32_16x16x32_bf16 v[16:19], v[192:195], v[64:67], v[16:19]
  ds_read_b64_tr_b16 v[54:55], v11 offset:18688
  v_mul_f32 v36, v36, v44
  v_mfma_f32_16x16x32_bf16 v[24:27], v[196:199], v[64:67], v[24:27]
  ds_read_b64_tr_b16 v[56:57], v13 offset:26624
  v_mul_f32 v37, v37, v45
  v_mfma_f32_16x16x32_bf16 v[28:31], v[196:199], v[68:71], v[28:31]
  ds_read_b64_tr_b16 v[58:59], v13 offset:26880
  v_mfma_f32_16x16x32_bf16 v[20:23], v[192:195], v[68:71], v[20:23]
  ds_read_b64_tr_b16 v[60:61], v11 offset:26624
  s_waitcnt lgkmcnt(11)
  v_mfma_f32_16x16x32_bf16 v[16:19], v[104:107], v[224:227], v[16:19]
  ds_read_b64_tr_b16 v[62:63], v11 offset:26880
  v_mul_f32 v38, v38, v46
  v_mfma_f32_16x16x32_bf16 v[24:27], v[108:111], v[224:227], v[24:27]
  ds_read_b64_tr_b16 v[64:65], v13 offset:4096
  v_mul_f32 v39, v39, v47
  v_mfma_f32_16x16x32_bf16 v[28:31], v[108:111], v[228:231], v[28:31]
  ds_read_b64_tr_b16 v[66:67], v13 offset:4352
  v_mfma_f32_16x16x32_bf16 v[20:23], v[104:107], v[228:231], v[20:23]
  ds_read_b64_tr_b16 v[68:69], v11 offset:4096
  s_waitcnt lgkmcnt(11)
  v_mfma_f32_16x16x32_bf16 v[16:19], v[136:139], v[232:235], v[16:19]
  ds_read_b64_tr_b16 v[70:71], v11 offset:4352
  v_cvt_pk_bf16_f32 v84, v32, v33
  v_mfma_f32_16x16x32_bf16 v[24:27], v[140:143], v[232:235], v[24:27]
  ds_read_b64_tr_b16 v[224:225], v13 offset:12288
  v_cvt_pk_bf16_f32 v85, v34, v35
  v_mfma_f32_16x16x32_bf16 v[28:31], v[140:143], v[236:239], v[28:31]
  ds_read_b64_tr_b16 v[226:227], v13 offset:12544
  v_mfma_f32_16x16x32_bf16 v[20:23], v[136:139], v[236:239], v[20:23]
  ds_read_b64_tr_b16 v[228:229], v11 offset:12288
  s_waitcnt lgkmcnt(11)
  v_mfma_f32_16x16x32_bf16 v[16:19], v[168:171], v[48:51], v[16:19]
  ds_read_b64_tr_b16 v[230:231], v11 offset:12544
  v_cvt_pk_bf16_f32 v86, v36, v37
  v_mfma_f32_16x16x32_bf16 v[24:27], v[172:175], v[48:51], v[24:27]
  ds_read_b64_tr_b16 v[232:233], v13 offset:20480
  v_cvt_pk_bf16_f32 v87, v38, v39
  v_mfma_f32_16x16x32_bf16 v[28:31], v[172:175], v[52:55], v[28:31]
  ds_read_b64_tr_b16 v[234:235], v13 offset:20736
  v_mfma_f32_16x16x32_bf16 v[20:23], v[168:171], v[52:55], v[20:23]
  ds_read_b64_tr_b16 v[236:237], v11 offset:20480
  s_waitcnt lgkmcnt(11)
  v_mfma_f32_16x16x32_bf16 v[16:19], v[200:203], v[56:59], v[16:19]
  ds_read_b64_tr_b16 v[238:239], v11 offset:20736
  v_permlane16_swap_b32 v84, v86
  v_mfma_f32_16x16x32_bf16 v[24:27], v[204:207], v[56:59], v[24:27]
  ds_read_b64_tr_b16 v[48:49], v13 offset:28672
  v_permlane16_swap_b32 v85, v87
  v_mfma_f32_16x16x32_bf16 v[28:31], v[204:207], v[60:63], v[28:31]
  ds_read_b64_tr_b16 v[50:51], v13 offset:28928
  v_mfma_f32_16x16x32_bf16 v[20:23], v[200:203], v[60:63], v[20:23]
  ds_read_b64_tr_b16 v[52:53], v11 offset:28672
  s_waitcnt lgkmcnt(11)
  v_mfma_f32_16x16x32_bf16 v[16:19], v[112:115], v[64:67], v[16:19]
  ds_read_b64_tr_b16 v[54:55], v11 offset:28928
  buffer_store_dwordx4 v[80:83], v3, s[60:63], s5 offen sc1
  v_mfma_f32_16x16x32_bf16 v[24:27], v[116:119], v[64:67], v[24:27]
  ds_read_b64_tr_b16 v[56:57], v13 offset:6144
  buffer_store_dwordx4 v[84:87], v3, s[60:63], s5 offen offset:1024 sc1
  v_mfma_f32_16x16x32_bf16 v[28:31], v[116:119], v[68:71], v[28:31]
  ds_read_b64_tr_b16 v[58:59], v13 offset:6400
  v_mfma_f32_16x16x32_bf16 v[20:23], v[112:115], v[68:71], v[20:23]
  ds_read_b64_tr_b16 v[60:61], v11 offset:6144
  s_waitcnt lgkmcnt(11)
  v_mfma_f32_16x16x32_bf16 v[16:19], v[144:147], v[224:227], v[16:19]
  ds_read_b64_tr_b16 v[62:63], v11 offset:6400
  v_mfma_f32_16x16x32_bf16 v[24:27], v[148:151], v[224:227], v[24:27]
  ds_read_b64_tr_b16 v[64:65], v13 offset:14336
  v_mfma_f32_16x16x32_bf16 v[28:31], v[148:151], v[228:231], v[28:31]
  ds_read_b64_tr_b16 v[66:67], v13 offset:14592
  v_mfma_f32_16x16x32_bf16 v[20:23], v[144:147], v[228:231], v[20:23]
  ds_read_b64_tr_b16 v[68:69], v11 offset:14336
  s_waitcnt lgkmcnt(11)
  v_mfma_f32_16x16x32_bf16 v[16:19], v[176:179], v[232:235], v[16:19]
  ds_read_b64_tr_b16 v[70:71], v11 offset:14592
  v_mfma_f32_16x16x32_bf16 v[24:27], v[180:183], v[232:235], v[24:27]
  ds_read_b64_tr_b16 v[224:225], v13 offset:22528
  v_mfma_f32_16x16x32_bf16 v[28:31], v[180:183], v[236:239], v[28:31]
  ds_read_b64_tr_b16 v[226:227], v13 offset:22784
  v_mfma_f32_16x16x32_bf16 v[20:23], v[176:179], v[236:239], v[20:23]
  ds_read_b64_tr_b16 v[228:229], v11 offset:22528
  s_waitcnt lgkmcnt(11)
  v_mfma_f32_16x16x32_bf16 v[16:19], v[208:211], v[48:51], v[16:19]
  ds_read_b64_tr_b16 v[230:231], v11 offset:22784
  v_mfma_f32_16x16x32_bf16 v[24:27], v[212:215], v[48:51], v[24:27]
  ds_read_b64_tr_b16 v[232:233], v13 offset:30720
  v_mfma_f32_16x16x32_bf16 v[28:31], v[212:215], v[52:55], v[28:31]
  ds_read_b64_tr_b16 v[234:235], v13 offset:30976
  v_mfma_f32_16x16x32_bf16 v[20:23], v[208:211], v[52:55], v[20:23]
  ds_read_b64_tr_b16 v[236:237], v11 offset:30720
  s_waitcnt lgkmcnt(11)
  v_mfma_f32_16x16x32_bf16 v[16:19], v[120:123], v[56:59], v[16:19]
  ds_read_b64_tr_b16 v[238:239], v11 offset:30976
  v_mfma_f32_16x16x32_bf16 v[24:27], v[124:127], v[56:59], v[24:27]
  v_mfma_f32_16x16x32_bf16 v[28:31], v[124:127], v[60:63], v[28:31]
  v_mfma_f32_16x16x32_bf16 v[20:23], v[120:123], v[60:63], v[20:23]
  s_waitcnt lgkmcnt(8)
  v_mfma_f32_16x16x32_bf16 v[16:19], v[152:155], v[64:67], v[16:19]
  v_mfma_f32_16x16x32_bf16 v[24:27], v[156:159], v[64:67], v[24:27]
  v_mfma_f32_16x16x32_bf16 v[28:31], v[156:159], v[68:71], v[28:31]
  v_mfma_f32_16x16x32_bf16 v[20:23], v[152:155], v[68:71], v[20:23]
  s_waitcnt lgkmcnt(0)
  s_barrier
  s_waitcnt lgkmcnt(4)
  v_mfma_f32_16x16x32_bf16 v[16:19], v[184:187], v[224:227], v[16:19]
  ds_read_b64_tr_b16 v[48:49], v12 offset:0
  ds_read_b64_tr_b16 v[50:51], v12 offset:256
  v_mfma_f32_16x16x32_bf16 v[24:27], v[188:191], v[224:227], v[24:27]
  ds_read_b64_tr_b16 v[52:53], v10 offset:0
  ds_read_b64_tr_b16 v[54:55], v10 offset:256
  v_mfma_f32_16x16x32_bf16 v[28:31], v[188:191], v[228:231], v[28:31]
  ds_read_b64_tr_b16 v[56:57], v12 offset:8192
  ds_read_b64_tr_b16 v[58:59], v12 offset:8448
  v_mfma_f32_16x16x32_bf16 v[20:23], v[184:187], v[228:231], v[20:23]
  ds_read_b64_tr_b16 v[60:61], v10 offset:8192
  ds_read_b64_tr_b16 v[62:63], v10 offset:8448
  s_waitcnt lgkmcnt(8)
  v_mfma_f32_16x16x32_bf16 v[16:19], v[216:219], v[232:235], v[16:19]
  ds_read_b64_tr_b16 v[64:65], v12 offset:16384
  ds_read_b64_tr_b16 v[66:67], v12 offset:16640
  v_mfma_f32_16x16x32_bf16 v[24:27], v[220:223], v[232:235], v[24:27]
  ds_read_b64_tr_b16 v[68:69], v10 offset:16384
  ds_read_b64_tr_b16 v[70:71], v10 offset:16640
  v_mfma_f32_16x16x32_bf16 v[28:31], v[220:223], v[236:239], v[28:31]
  ds_read_b64_tr_b16 v[224:225], v12 offset:24576
  ds_read_b64_tr_b16 v[226:227], v12 offset:24832
  v_mfma_f32_16x16x32_bf16 v[20:23], v[216:219], v[236:239], v[20:23]
  ds_read_b64_tr_b16 v[228:229], v10 offset:24576
  s_waitcnt lgkmcnt(11)
  v_mfma_f32_16x16x32_bf16 v[32:35], v[96:99], v[48:51], 0
  ds_read_b64_tr_b16 v[230:231], v10 offset:24832
  v_mfma_f32_16x16x32_bf16 v[40:43], v[100:103], v[48:51], 0
  ds_read_b64_tr_b16 v[232:233], v12 offset:2048
  v_mfma_f32_16x16x32_bf16 v[44:47], v[100:103], v[52:55], 0
  ds_read_b64_tr_b16 v[234:235], v12 offset:2304
  v_mfma_f32_16x16x32_bf16 v[36:39], v[96:99], v[52:55], 0
  ds_read_b64_tr_b16 v[236:237], v10 offset:2048
  s_waitcnt lgkmcnt(11)
  v_mfma_f32_16x16x32_bf16 v[32:35], v[128:131], v[56:59], v[32:35]
  ds_read_b64_tr_b16 v[238:239], v10 offset:2304
  v_mul_f32 v16, v16, v24
  v_mfma_f32_16x16x32_bf16 v[40:43], v[132:135], v[56:59], v[40:43]
  ds_read_b64_tr_b16 v[48:49], v12 offset:10240
  v_mul_f32 v17, v17, v25
  v_mfma_f32_16x16x32_bf16 v[44:47], v[132:135], v[60:63], v[44:47]
  ds_read_b64_tr_b16 v[50:51], v12 offset:10496
  v_mfma_f32_16x16x32_bf16 v[36:39], v[128:131], v[60:63], v[36:39]
  ds_read_b64_tr_b16 v[52:53], v10 offset:10240
  s_waitcnt lgkmcnt(11)
  v_mfma_f32_16x16x32_bf16 v[32:35], v[160:163], v[64:67], v[32:35]
  ds_read_b64_tr_b16 v[54:55], v10 offset:10496
  v_mul_f32 v18, v18, v26
  v_mfma_f32_16x16x32_bf16 v[40:43], v[164:167], v[64:67], v[40:43]
  ds_read_b64_tr_b16 v[56:57], v12 offset:18432
  v_mul_f32 v19, v19, v27
  v_mfma_f32_16x16x32_bf16 v[44:47], v[164:167], v[68:71], v[44:47]
  ds_read_b64_tr_b16 v[58:59], v12 offset:18688
  v_mfma_f32_16x16x32_bf16 v[36:39], v[160:163], v[68:71], v[36:39]
  ds_read_b64_tr_b16 v[60:61], v10 offset:18432
  s_waitcnt lgkmcnt(11)
  v_mfma_f32_16x16x32_bf16 v[32:35], v[192:195], v[224:227], v[32:35]
  ds_read_b64_tr_b16 v[62:63], v10 offset:18688
  v_mul_f32 v20, v20, v28
  v_mfma_f32_16x16x32_bf16 v[40:43], v[196:199], v[224:227], v[40:43]
  ds_read_b64_tr_b16 v[64:65], v12 offset:26624
  v_mul_f32 v21, v21, v29
  v_mfma_f32_16x16x32_bf16 v[44:47], v[196:199], v[228:231], v[44:47]
  ds_read_b64_tr_b16 v[66:67], v12 offset:26880
  v_mfma_f32_16x16x32_bf16 v[36:39], v[192:195], v[228:231], v[36:39]
  ds_read_b64_tr_b16 v[68:69], v10 offset:26624
  s_waitcnt lgkmcnt(11)
  v_mfma_f32_16x16x32_bf16 v[32:35], v[104:107], v[232:235], v[32:35]
  ds_read_b64_tr_b16 v[70:71], v10 offset:26880
  v_mul_f32 v22, v22, v30
  v_mfma_f32_16x16x32_bf16 v[40:43], v[108:111], v[232:235], v[40:43]
  ds_read_b64_tr_b16 v[224:225], v12 offset:4096
  v_mul_f32 v23, v23, v31
  v_mfma_f32_16x16x32_bf16 v[44:47], v[108:111], v[236:239], v[44:47]
  ds_read_b64_tr_b16 v[226:227], v12 offset:4352
  v_mfma_f32_16x16x32_bf16 v[36:39], v[104:107], v[236:239], v[36:39]
  ds_read_b64_tr_b16 v[228:229], v10 offset:4096
  s_waitcnt lgkmcnt(11)
  v_mfma_f32_16x16x32_bf16 v[32:35], v[136:139], v[48:51], v[32:35]
  ds_read_b64_tr_b16 v[230:231], v10 offset:4352
  v_cvt_pk_bf16_f32 v80, v16, v17
  v_mfma_f32_16x16x32_bf16 v[40:43], v[140:143], v[48:51], v[40:43]
  ds_read_b64_tr_b16 v[232:233], v12 offset:12288
  v_cvt_pk_bf16_f32 v81, v18, v19
  v_mfma_f32_16x16x32_bf16 v[44:47], v[140:143], v[52:55], v[44:47]
  ds_read_b64_tr_b16 v[234:235], v12 offset:12544
  v_mfma_f32_16x16x32_bf16 v[36:39], v[136:139], v[52:55], v[36:39]
  ds_read_b64_tr_b16 v[236:237], v10 offset:12288
  s_waitcnt lgkmcnt(11)
  v_mfma_f32_16x16x32_bf16 v[32:35], v[168:171], v[56:59], v[32:35]
  ds_read_b64_tr_b16 v[238:239], v10 offset:12544
  v_cvt_pk_bf16_f32 v82, v20, v21
  v_mfma_f32_16x16x32_bf16 v[40:43], v[172:175], v[56:59], v[40:43]
  ds_read_b64_tr_b16 v[48:49], v12 offset:20480
  v_cvt_pk_bf16_f32 v83, v22, v23
  v_mfma_f32_16x16x32_bf16 v[44:47], v[172:175], v[60:63], v[44:47]
  ds_read_b64_tr_b16 v[50:51], v12 offset:20736
  v_mfma_f32_16x16x32_bf16 v[36:39], v[168:171], v[60:63], v[36:39]
  ds_read_b64_tr_b16 v[52:53], v10 offset:20480
  s_waitcnt lgkmcnt(11)
  v_mfma_f32_16x16x32_bf16 v[32:35], v[200:203], v[64:67], v[32:35]
  ds_read_b64_tr_b16 v[54:55], v10 offset:20736
  v_permlane16_swap_b32 v80, v82
  v_mfma_f32_16x16x32_bf16 v[40:43], v[204:207], v[64:67], v[40:43]
  ds_read_b64_tr_b16 v[56:57], v12 offset:28672
  v_permlane16_swap_b32 v81, v83
  v_mfma_f32_16x16x32_bf16 v[44:47], v[204:207], v[68:71], v[44:47]
  ds_read_b64_tr_b16 v[58:59], v12 offset:28928
  v_mfma_f32_16x16x32_bf16 v[36:39], v[200:203], v[68:71], v[36:39]
  ds_read_b64_tr_b16 v[60:61], v10 offset:28672
  s_waitcnt lgkmcnt(11)
  v_mfma_f32_16x16x32_bf16 v[32:35], v[112:115], v[224:227], v[32:35]
  ds_read_b64_tr_b16 v[62:63], v10 offset:28928
  s_bfe_u32 s5, s49, 0x20001
  v_mfma_f32_16x16x32_bf16 v[40:43], v[116:119], v[224:227], v[40:43]
  ds_read_b64_tr_b16 v[64:65], v12 offset:6144
  s_mul_i32 s5, s5, 229376
  v_mfma_f32_16x16x32_bf16 v[44:47], v[116:119], v[228:231], v[44:47]
  ds_read_b64_tr_b16 v[66:67], v12 offset:6400
  v_mfma_f32_16x16x32_bf16 v[36:39], v[112:115], v[228:231], v[36:39]
  ds_read_b64_tr_b16 v[68:69], v10 offset:6144
  s_waitcnt lgkmcnt(11)
  v_mfma_f32_16x16x32_bf16 v[32:35], v[144:147], v[232:235], v[32:35]
  ds_read_b64_tr_b16 v[70:71], v10 offset:6400
  s_lshr_b32 s49, s49, 8
  v_mfma_f32_16x16x32_bf16 v[40:43], v[148:151], v[232:235], v[40:43]
  ds_read_b64_tr_b16 v[224:225], v12 offset:14336
  v_mfma_f32_16x16x32_bf16 v[44:47], v[148:151], v[236:239], v[44:47]
  ds_read_b64_tr_b16 v[226:227], v12 offset:14592
  v_mfma_f32_16x16x32_bf16 v[36:39], v[144:147], v[236:239], v[36:39]
  ds_read_b64_tr_b16 v[228:229], v10 offset:14336
  s_waitcnt lgkmcnt(11)
  v_mfma_f32_16x16x32_bf16 v[32:35], v[176:179], v[48:51], v[32:35]
  ds_read_b64_tr_b16 v[230:231], v10 offset:14592
  v_mfma_f32_16x16x32_bf16 v[40:43], v[180:183], v[48:51], v[40:43]
  ds_read_b64_tr_b16 v[232:233], v12 offset:22528
  v_mfma_f32_16x16x32_bf16 v[44:47], v[180:183], v[52:55], v[44:47]
  ds_read_b64_tr_b16 v[234:235], v12 offset:22784
  v_mfma_f32_16x16x32_bf16 v[36:39], v[176:179], v[52:55], v[36:39]
  ds_read_b64_tr_b16 v[236:237], v10 offset:22528
  s_waitcnt lgkmcnt(11)
  v_mfma_f32_16x16x32_bf16 v[32:35], v[208:211], v[56:59], v[32:35]
  ds_read_b64_tr_b16 v[238:239], v10 offset:22784
  v_mfma_f32_16x16x32_bf16 v[40:43], v[212:215], v[56:59], v[40:43]
  ds_read_b64_tr_b16 v[48:49], v12 offset:30720
  v_mfma_f32_16x16x32_bf16 v[44:47], v[212:215], v[60:63], v[44:47]
  ds_read_b64_tr_b16 v[50:51], v12 offset:30976
  v_mfma_f32_16x16x32_bf16 v[36:39], v[208:211], v[60:63], v[36:39]
  ds_read_b64_tr_b16 v[52:53], v10 offset:30720
  s_waitcnt lgkmcnt(11)
  v_mfma_f32_16x16x32_bf16 v[32:35], v[120:123], v[64:67], v[32:35]
  ds_read_b64_tr_b16 v[54:55], v10 offset:30976
  v_mfma_f32_16x16x32_bf16 v[40:43], v[124:127], v[64:67], v[40:43]
  v_mfma_f32_16x16x32_bf16 v[44:47], v[124:127], v[68:71], v[44:47]
  v_mfma_f32_16x16x32_bf16 v[36:39], v[120:123], v[68:71], v[36:39]
  s_waitcnt lgkmcnt(8)
  v_mfma_f32_16x16x32_bf16 v[32:35], v[152:155], v[224:227], v[32:35]
  v_mfma_f32_16x16x32_bf16 v[40:43], v[156:159], v[224:227], v[40:43]
  v_mfma_f32_16x16x32_bf16 v[44:47], v[156:159], v[228:231], v[44:47]
  v_mfma_f32_16x16x32_bf16 v[36:39], v[152:155], v[228:231], v[36:39]
  s_waitcnt vmcnt(0) lgkmcnt(0)
  s_barrier
  s_waitcnt lgkmcnt(4)
  v_mfma_f32_16x16x32_bf16 v[32:35], v[184:187], v[232:235], v[32:35]
  ds_read_b64_tr_b16 v[56:57], v12 offset:32768
  ds_read_b64_tr_b16 v[58:59], v12 offset:33024
  v_mfma_f32_16x16x32_bf16 v[40:43], v[188:191], v[232:235], v[40:43]
  ds_read_b64_tr_b16 v[60:61], v10 offset:32768
  ds_read_b64_tr_b16 v[62:63], v10 offset:33024
  v_mfma_f32_16x16x32_bf16 v[44:47], v[188:191], v[236:239], v[44:47]
  ds_read_b64_tr_b16 v[64:65], v12 offset:40960
  ds_read_b64_tr_b16 v[66:67], v12 offset:41216
  v_mfma_f32_16x16x32_bf16 v[36:39], v[184:187], v[236:239], v[36:39]
  ds_read_b64_tr_b16 v[68:69], v10 offset:40960
  ds_read_b64_tr_b16 v[70:71], v10 offset:41216
  s_cmp_lg_u32 s11, 0
  s_cbranch_scc1 hf5
  s_mov_b64 exec, 1
  global_store_dword v5, v6, s[46:47] sc1
  s_mov_b64 exec, -1
hf5:
  v_add_u32 v5, 0x8000, v5
  s_waitcnt lgkmcnt(8)
  v_mfma_f32_16x16x32_bf16 v[32:35], v[216:219], v[48:51], v[32:35]
  ds_read_b64_tr_b16 v[224:225], v12 offset:49152
  ds_read_b64_tr_b16 v[226:227], v12 offset:49408
  v_mfma_f32_16x16x32_bf16 v[40:43], v[220:223], v[48:51], v[40:43]
  ds_read_b64_tr_b16 v[228:229], v10 offset:49152
  ds_read_b64_tr_b16 v[230:231], v10 offset:49408
  v_mfma_f32_16x16x32_bf16 v[44:47], v[220:223], v[52:55], v[44:47]
  ds_read_b64_tr_b16 v[232:233], v12 offset:57344
  ds_read_b64_tr_b16 v[234:235], v12 offset:57600
  v_mfma_f32_16x16x32_bf16 v[36:39], v[216:219], v[52:55], v[36:39]
  ds_read_b64_tr_b16 v[236:237], v10 offset:57344
  s_waitcnt lgkmcnt(11)
  v_mfma_f32_16x16x32_bf16 v[16:19], v[96:99], v[56:59], 0
  ds_read_b64_tr_b16 v[238:239], v10 offset:57600
  v_mfma_f32_16x16x32_bf16 v[24:27], v[100:103], v[56:59], 0
  ds_read_b64_tr_b16 v[48:49], v12 offset:34816
  v_mfma_f32_16x16x32_bf16 v[28:31], v[100:103], v[60:63], 0
  ds_read_b64_tr_b16 v[50:51], v12 offset:35072
  v_mfma_f32_16x16x32_bf16 v[20:23], v[96:99], v[60:63], 0
  ds_read_b64_tr_b16 v[52:53], v10 offset:34816
  s_waitcnt lgkmcnt(11)
  v_mfma_f32_16x16x32_bf16 v[16:19], v[128:131], v[64:67], v[16:19]
  ds_read_b64_tr_b16 v[54:55], v10 offset:35072
  v_mul_f32 v32, v32, v40
  v_mfma_f32_16x16x32_bf16 v[24:27], v[132:135], v[64:67], v[24:27]
  ds_read_b64_tr_b16 v[56:57], v12 offset:43008
  v_mul_f32 v33, v33, v41
  v_mfma_f32_16x16x32_bf16 v[28:31], v[132:135], v[68:71], v[28:31]
  ds_read_b64_tr_b16 v[58:59], v12 offset:43264
  v_mfma_f32_16x16x32_bf16 v[20:23], v[128:131], v[68:71], v[20:23]
  ds_read_b64_tr_b16 v[60:61], v10 offset:43008
  s_waitcnt lgkmcnt(11)
  v_mfma_f32_16x16x32_bf16 v[16:19], v[160:163], v[224:227], v[16:19]
  ds_read_b64_tr_b16 v[62:63], v10 offset:43264
  v_mul_f32 v34, v34, v42
  v_mfma_f32_16x16x32_bf16 v[24:27], v[164:167], v[224:227], v[24:27]
  ds_read_b64_tr_b16 v[64:65], v12 offset:51200
  v_mul_f32 v35, v35, v43
  v_mfma_f32_16x16x32_bf16 v[28:31], v[164:167], v[228:231], v[28:31]
  ds_read_b64_tr_b16 v[66:67], v12 offset:51456
  v_mfma_f32_16x16x32_bf16 v[20:23], v[160:163], v[228:231], v[20:23]
  ds_read_b64_tr_b16 v[68:69], v10 offset:51200
  s_waitcnt lgkmcnt(11)
  v_mfma_f32_16x16x32_bf16 v[16:19], v[192:195], v[232:235], v[16:19]
  ds_read_b64_tr_b16 v[70:71], v10 offset:51456
  v_mul_f32 v36, v36, v44
  v_mfma_f32_16x16x32_bf16 v[24:27], v[196:199], v[232:235], v[24:27]
  ds_read_b64_tr_b16 v[224:225], v12 offset:59392
  v_mul_f32 v37, v37, v45
  v_mfma_f32_16x16x32_bf16 v[28:31], v[196:199], v[236:239], v[28:31]
  ds_read_b64_tr_b16 v[226:227], v12 offset:59648
  v_mfma_f32_16x16x32_bf16 v[20:23], v[192:195], v[236:239], v[20:23]
  ds_read_b64_tr_b16 v[228:229], v10 offset:59392
  s_waitcnt lgkmcnt(11)
  v_mfma_f32_16x16x32_bf16 v[16:19], v[104:107], v[48:51], v[16:19]
  ds_read_b64_tr_b16 v[230:231], v10 offset:59648
  v_mul_f32 v38, v38, v46
  v_mfma_f32_16x16x32_bf16 v[24:27], v[108:111], v[48:51], v[24:27]
  ds_read_b64_tr_b16 v[232:233], v12 offset:36864
  v_mul_f32 v39, v39, v47
  v_mfma_f32_16x16x32_bf16 v[28:31], v[108:111], v[52:55], v[28:31]
  ds_read_b64_tr_b16 v[234:235], v12 offset:37120
  v_mfma_f32_16x16x32_bf16 v[20:23], v[104:107], v[52:55], v[20:23]
  ds_read_b64_tr_b16 v[236:237], v10 offset:36864
  s_waitcnt lgkmcnt(11)
  v_mfma_f32_16x16x32_bf16 v[16:19], v[136:139], v[56:59], v[16:19]
  ds_read_b64_tr_b16 v[238:239], v10 offset:37120
  v_cvt_pk_bf16_f32 v84, v32, v33
  v_mfma_f32_16x16x32_bf16 v[24:27], v[140:143], v[56:59], v[24:27]
  ds_read_b64_tr_b16 v[48:49], v12 offset:45056
  v_cvt_pk_bf16_f32 v85, v34, v35
  v_mfma_f32_16x16x32_bf16 v[28:31], v[140:143], v[60:63], v[28:31]
  ds_read_b64_tr_b16 v[50:51], v12 offset:45312
  v_mfma_f32_16x16x32_bf16 v[20:23], v[136:139], v[60:63], v[20:23]
  ds_read_b64_tr_b16 v[52:53], v10 offset:45056
  s_waitcnt lgkmcnt(11)
  v_mfma_f32_16x16x32_bf16 v[16:19], v[168:171], v[64:67], v[16:19]
  ds_read_b64_tr_b16 v[54:55], v10 offset:45312
  v_cvt_pk_bf16_f32 v86, v36, v37
  v_mfma_f32_16x16x32_bf16 v[24:27], v[172:175], v[64:67], v[24:27]
  ds_read_b64_tr_b16 v[56:57], v12 offset:53248
  v_cvt_pk_bf16_f32 v87, v38, v39
  v_mfma_f32_16x16x32_bf16 v[28:31], v[172:175], v[68:71], v[28:31]
  ds_read_b64_tr_b16 v[58:59], v12 offset:53504
  v_mfma_f32_16x16x32_bf16 v[20:23], v[168:171], v[68:71], v[20:23]
  ds_read_b64_tr_b16 v[60:61], v10 offset:53248
  s_waitcnt lgkmcnt(11)
  v_mfma_f32_16x16x32_bf16 v[16:19], v[200:203], v[224:227], v[16:19]
  ds_read_b64_tr_b16 v[62:63], v10 offset:53504
  v_permlane16_swap_b32 v84, v86
  v_mfma_f32_16x16x32_bf16 v[24:27], v[204:207], v[224:227], v[24:27]
  ds_read_b64_tr_b16 v[64:65], v12 offset:61440
  v_permlane16_swap_b32 v85, v87
  v_mfma_f32_16x16x32_bf16 v[28:31], v[204:207], v[228:231], v[28:31]
  ds_read_b64_tr_b16 v[66:67], v12 offset:61696
  v_mfma_f32_16x16x32_bf16 v[20:23], v[200:203], v[228:231], v[20:23]
  ds_read_b64_tr_b16 v[68:69], v10 offset:61440
  s_waitcnt lgkmcnt(11)
  v_mfma_f32_16x16x32_bf16 v[16:19], v[112:115], v[232:235], v[16:19]
  ds_read_b64_tr_b16 v[70:71], v10 offset:61696
  buffer_store_dwordx4 v[80:83], v3, s[60:63], s5 offen sc1
  v_mfma_f32_16x16x32_bf16 v[24:27], v[116:119], v[232:235], v[24:27]
  ds_read_b64_tr_b16 v[224:225], v12 offset:38912
  buffer_store_dwordx4 v[84:87], v3, s[60:63], s5 offen offset:1024 sc1
  v_mfma_f32_16x16x32_bf16 v[28:31], v[116:119], v[236:239], v[28:31]
  ds_read_b64_tr_b16 v[226:227], v12 offset:39168
  v_mfma_f32_16x16x32_bf16 v[20:23], v[112:115], v[236:239], v[20:23]
  ds_read_b64_tr_b16 v[228:229], v10 offset:38912
  s_waitcnt lgkmcnt(11)
  v_mfma_f32_16x16x32_bf16 v[16:19], v[144:147], v[48:51], v[16:19]
  ds_read_b64_tr_b16 v[230:231], v10 offset:39168
  v_mfma_f32_16x16x32_bf16 v[24:27], v[148:151], v[48:51], v[24:27]
  ds_read_b64_tr_b16 v[232:233], v12 offset:47104
  v_mfma_f32_16x16x32_bf16 v[28:31], v[148:151], v[52:55], v[28:31]
  ds_read_b64_tr_b16 v[234:235], v12 offset:47360
  v_mfma_f32_16x16x32_bf16 v[20:23], v[144:147], v[52:55], v[20:23]
  ds_read_b64_tr_b16 v[236:237], v10 offset:47104
  s_waitcnt lgkmcnt(11)
  v_mfma_f32_16x16x32_bf16 v[16:19], v[176:179], v[56:59], v[16:19]
  ds_read_b64_tr_b16 v[238:239], v10 offset:47360
  v_mfma_f32_16x16x32_bf16 v[24:27], v[180:183], v[56:59], v[24:27]
  ds_read_b64_tr_b16 v[48:49], v12 offset:55296
  v_mfma_f32_16x16x32_bf16 v[28:31], v[180:183], v[60:63], v[28:31]
  ds_read_b64_tr_b16 v[50:51], v12 offset:55552
  v_mfma_f32_16x16x32_bf16 v[20:23], v[176:179], v[60:63], v[20:23]
  ds_read_b64_tr_b16 v[52:53], v10 offset:55296
  s_waitcnt lgkmcnt(11)
  v_mfma_f32_16x16x32_bf16 v[16:19], v[208:211], v[64:67], v[16:19]
  ds_read_b64_tr_b16 v[54:55], v10 offset:55552
  v_mfma_f32_16x16x32_bf16 v[24:27], v[212:215], v[64:67], v[24:27]
  ds_read_b64_tr_b16 v[56:57], v12 offset:63488
  v_mfma_f32_16x16x32_bf16 v[28:31], v[212:215], v[68:71], v[28:31]
  ds_read_b64_tr_b16 v[58:59], v12 offset:63744
  v_mfma_f32_16x16x32_bf16 v[20:23], v[208:211], v[68:71], v[20:23]
  ds_read_b64_tr_b16 v[60:61], v10 offset:63488
  s_waitcnt lgkmcnt(11)
  v_mfma_f32_16x16x32_bf16 v[16:19], v[120:123], v[224:227], v[16:19]
  ds_read_b64_tr_b16 v[62:63], v10 offset:63744
  v_mfma_f32_16x16x32_bf16 v[24:27], v[124:127], v[224:227], v[24:27]
  v_mfma_f32_16x16x32_bf16 v[28:31], v[124:127], v[228:231], v[28:31]
  v_mfma_f32_16x16x32_bf16 v[20:23], v[120:123], v[228:231], v[20:23]
  s_waitcnt lgkmcnt(8)
  v_mfma_f32_16x16x32_bf16 v[16:19], v[152:155], v[232:235], v[16:19]
  v_mfma_f32_16x16x32_bf16 v[24:27], v[156:159], v[232:235], v[24:27]
  v_mfma_f32_16x16x32_bf16 v[28:31], v[156:159], v[236:239], v[28:31]
  v_mfma_f32_16x16x32_bf16 v[20:23], v[152:155], v[236:239], v[20:23]
  s_waitcnt lgkmcnt(0)
  s_barrier
  s_waitcnt lgkmcnt(4)
  v_mfma_f32_16x16x32_bf16 v[16:19], v[184:187], v[48:51], v[16:19]
  ds_read_b64_tr_b16 v[64:65], v13 offset:0
  ds_read_b64_tr_b16 v[66:67], v13 offset:256
  v_mfma_f32_16x16x32_bf16 v[24:27], v[188:191], v[48:51], v[24:27]
  ds_read_b64_tr_b16 v[68:69], v11 offset:0
  ds_read_b64_tr_b16 v[70:71], v11 offset:256
  v_mfma_f32_16x16x32_bf16 v[28:31], v[188:191], v[52:55], v[28:31]
  ds_read_b64_tr_b16 v[224:225], v13 offset:8192
  ds_read_b64_tr_b16 v[226:227], v13 offset:8448
  v_mfma_f32_16x16x32_bf16 v[20:23], v[184:187], v[52:55], v[20:23]
  ds_read_b64_tr_b16 v[228:229], v11 offset:8192
  ds_read_b64_tr_b16 v[230:231], v11 offset:8448
  s_waitcnt lgkmcnt(8)
  v_mfma_f32_16x16x32_bf16 v[16:19], v[216:219], v[56:59], v[16:19]
  ds_read_b64_tr_b16 v[232:233], v13 offset:16384
  ds_read_b64_tr_b16 v[234:235], v13 offset:16640
  v_mfma_f32_16x16x32_bf16 v[24:27], v[220:223], v[56:59], v[24:27]
  ds_read_b64_tr_b16 v[236:237], v11 offset:16384
  ds_read_b64_tr_b16 v[238:239], v11 offset:16640
  v_mfma_f32_16x16x32_bf16 v[28:31], v[220:223], v[60:63], v[28:31]
  ds_read_b64_tr_b16 v[48:49], v13 offset:24576
  ds_read_b64_tr_b16 v[50:51], v13 offset:24832
  v_mfma_f32_16x16x32_bf16 v[20:23], v[216:219], v[60:63], v[20:23]
  ds_read_b64_tr_b16 v[52:53], v11 offset:24576
  s_waitcnt lgkmcnt(11)
  v_mfma_f32_16x16x32_bf16 v[32:35], v[96:99], v[64:67], 0
  ds_read_b64_tr_b16 v[54:55], v11 offset:24832
  v_mfma_f32_16x16x32_bf16 v[40:43], v[100:103], v[64:67], 0
  ds_read_b64_tr_b16 v[56:57], v13 offset:2048
  v_mfma_f32_16x16x32_bf16 v[44:47], v[100:103], v[68:71], 0
  ds_read_b64_tr_b16 v[58:59], v13 offset:2304
  v_mfma_f32_16x16x32_bf16 v[36:39], v[96:99], v[68:71], 0
  ds_read_b64_tr_b16 v[60:61], v11 offset:2048
  s_waitcnt lgkmcnt(11)
  v_mfma_f32_16x16x32_bf16 v[32:35], v[128:131], v[224:227], v[32:35]
  ds_read_b64_tr_b16 v[62:63], v11 offset:2304
  v_mul_f32 v16, v16, v24
  v_mfma_f32_16x16x32_bf16 v[40:43], v[132:135], v[224:227], v[40:43]
  ds_read_b64_tr_b16 v[64:65], v13 offset:10240
  v_mul_f32 v17, v17, v25
  v_mfma_f32_16x16x32_bf16 v[44:47], v[132:135], v[228:231], v[44:47]
  ds_read_b64_tr_b16 v[66:67], v13 offset:10496
  v_mfma_f32_16x16x32_bf16 v[36:39], v[128:131], v[228:231], v[36:39]
  ds_read_b64_tr_b16 v[68:69], v11 offset:10240
  s_waitcnt lgkmcnt(11)
  v_mfma_f32_16x16x32_bf16 v[32:35], v[160:163], v[232:235], v[32:35]
  ds_read_b64_tr_b16 v[70:71], v11 offset:10496
  v_mul_f32 v18, v18, v26
  v_mfma_f32_16x16x32_bf16 v[40:43], v[164:167], v[232:235], v[40:43]
  ds_read_b64_tr_b16 v[224:225], v13 offset:18432
  v_mul_f32 v19, v19, v27
  v_mfma_f32_16x16x32_bf16 v[44:47], v[164:167], v[236:239], v[44:47]
  ds_read_b64_tr_b16 v[226:227], v13 offset:18688
  v_mfma_f32_16x16x32_bf16 v[36:39], v[160:163], v[236:239], v[36:39]
  ds_read_b64_tr_b16 v[228:229], v11 offset:18432
  s_waitcnt lgkmcnt(11)
  v_mfma_f32_16x16x32_bf16 v[32:35], v[192:195], v[48:51], v[32:35]
  ds_read_b64_tr_b16 v[230:231], v11 offset:18688
  v_mul_f32 v20, v20, v28
  v_mfma_f32_16x16x32_bf16 v[40:43], v[196:199], v[48:51], v[40:43]
  ds_read_b64_tr_b16 v[232:233], v13 offset:26624
  v_mul_f32 v21, v21, v29
  v_mfma_f32_16x16x32_bf16 v[44:47], v[196:199], v[52:55], v[44:47]
  ds_read_b64_tr_b16 v[234:235], v13 offset:26880
  v_mfma_f32_16x16x32_bf16 v[36:39], v[192:195], v[52:55], v[36:39]
  ds_read_b64_tr_b16 v[236:237], v11 offset:26624
  s_waitcnt lgkmcnt(11)
  v_mfma_f32_16x16x32_bf16 v[32:35], v[104:107], v[56:59], v[32:35]
  ds_read_b64_tr_b16 v[238:239], v11 offset:26880
  v_mul_f32 v22, v22, v30
  v_mfma_f32_16x16x32_bf16 v[40:43], v[108:111], v[56:59], v[40:43]
  ds_read_b64_tr_b16 v[48:49], v13 offset:4096
  v_mul_f32 v23, v23, v31
  v_mfma_f32_16x16x32_bf16 v[44:47], v[108:111], v[60:63], v[44:47]
  ds_read_b64_tr_b16 v[50:51], v13 offset:4352
  v_mfma_f32_16x16x32_bf16 v[36:39], v[104:107], v[60:63], v[36:39]
  ds_read_b64_tr_b16 v[52:53], v11 offset:4096
  s_waitcnt vmcnt(0)
  s_mov_b64 exec, 1
  ds_write_b32 v15, v6 offset:16
  ds_read_b128 v[240:243], v14 offset:16
  s_mov_b64 exec, -1
  s_waitcnt lgkmcnt(11)
  v_mfma_f32_16x16x32_bf16 v[32:35], v[136:139], v[64:67], v[32:35]
  ds_read_b64_tr_b16 v[54:55], v11 offset:4352
  v_cvt_pk_bf16_f32 v80, v16, v17
  v_mfma_f32_16x16x32_bf16 v[40:43], v[140:143], v[64:67], v[40:43]
  ds_read_b64_tr_b16 v[56:57], v13 offset:12288
  v_cvt_pk_bf16_f32 v81, v18, v19
  v_mfma_f32_16x16x32_bf16 v[44:47], v[140:143], v[68:71], v[44:47]
  ds_read_b64_tr_b16 v[58:59], v13 offset:12544
  v_mfma_f32_16x16x32_bf16 v[36:39], v[136:139], v[68:71], v[36:39]
  ds_read_b64_tr_b16 v[60:61], v11 offset:12288
  s_waitcnt lgkmcnt(11)
  v_mfma_f32_16x16x32_bf16 v[32:35], v[168:171], v[224:227], v[32:35]
  ds_read_b64_tr_b16 v[62:63], v11 offset:12544
  v_cvt_pk_bf16_f32 v82, v20, v21
  v_mfma_f32_16x16x32_bf16 v[40:43], v[172:175], v[224:227], v[40:43]
  ds_read_b64_tr_b16 v[64:65], v13 offset:20480
  v_cvt_pk_bf16_f32 v83, v22, v23
  v_mfma_f32_16x16x32_bf16 v[44:47], v[172:175], v[228:231], v[44:47]
  ds_read_b64_tr_b16 v[66:67], v13 offset:20736
  v_mfma_f32_16x16x32_bf16 v[36:39], v[168:171], v[228:231], v[36:39]
  ds_read_b64_tr_b16 v[68:69], v11 offset:20480
  s_waitcnt lgkmcnt(11)
  v_mfma_f32_16x16x32_bf16 v[32:35], v[200:203], v[232:235], v[32:35]
  ds_read_b64_tr_b16 v[70:71], v11 offset:20736
  v_permlane16_swap_b32 v80, v82
  v_mfma_f32_16x16x32_bf16 v[40:43], v[204:207], v[232:235], v[40:43]
  ds_read_b64_tr_b16 v[224:225], v13 offset:28672
  v_permlane16_swap_b32 v81, v83
  v_mfma_f32_16x16x32_bf16 v[44:47], v[204:207], v[236:239], v[44:47]
  ds_read_b64_tr_b16 v[226:227], v13 offset:28928
  v_mfma_f32_16x16x32_bf16 v[36:39], v[200:203], v[236:239], v[36:39]
  ds_read_b64_tr_b16 v[228:229], v11 offset:28672
  s_waitcnt lgkmcnt(11)
  v_mfma_f32_16x16x32_bf16 v[32:35], v[112:115], v[48:51], v[32:35]
  ds_read_b64_tr_b16 v[230:231], v11 offset:28928
  s_bfe_u32 s5, s49, 0x20001
  v_mfma_f32_16x16x32_bf16 v[40:43], v[116:119], v[48:51], v[40:43]
  ds_read_b64_tr_b16 v[232:233], v13 offset:6144
  s_mul_i32 s5, s5, 229376
  v_mfma_f32_16x16x32_bf16 v[44:47], v[116:119], v[52:55], v[44:47]
  ds_read_b64_tr_b16 v[234:235], v13 offset:6400
  v_mfma_f32_16x16x32_bf16 v[36:39], v[112:115], v[52:55], v[36:39]
  ds_read_b64_tr_b16 v[236:237], v11 offset:6144
  s_waitcnt lgkmcnt(11)
  v_mfma_f32_16x16x32_bf16 v[32:35], v[144:147], v[56:59], v[32:35]
  ds_read_b64_tr_b16 v[238:239], v11 offset:6400
  s_lshr_b32 s49, s49, 8
  v_mfma_f32_16x16x32_bf16 v[40:43], v[148:151], v[56:59], v[40:43]
  ds_read_b64_tr_b16 v[48:49], v13 offset:14336
  v_mfma_f32_16x16x32_bf16 v[44:47], v[148:151], v[60:63], v[44:47]
  ds_read_b64_tr_b16 v[50:51], v13 offset:14592
  v_mfma_f32_16x16x32_bf16 v[36:39], v[144:147], v[60:63], v[36:39]
  ds_read_b64_tr_b16 v[52:53], v11 offset:14336
  s_mov_b64 exec, 1
  v_cmpx_eq_u32 vcc, v6, v240
  v_cmpx_eq_u32 vcc, v6, v241
  v_cmpx_eq_u32 vcc, v6, v242
  v_cmpx_eq_u32 vcc, v6, v243
  s_cbranch_execz hfa
  global_store_dword v5, v6, s[46:47] sc1
hfa:
  s_mov_b64 exec, -1
  v_add_u32 v5, 0x8000, v5
  s_nop 1
  s_waitcnt lgkmcnt(11)
  v_mfma_f32_16x16x32_bf16 v[32:35], v[176:179], v[64:67], v[32:35]
  ds_read_b64_tr_b16 v[54:55], v11 offset:14592
  v_mfma_f32_16x16x32_bf16 v[40:43], v[180:183], v[64:67], v[40:43]
  ds_read_b64_tr_b16 v[56:57], v13 offset:22528
  v_mfma_f32_16x16x32_bf16 v[44:47], v[180:183], v[68:71], v[44:47]
  ds_read_b64_tr_b16 v[58:59], v13 offset:22784
  v_mfma_f32_16x16x32_bf16 v[36:39], v[176:179], v[68:71], v[36:39]
  ds_read_b64_tr_b16 v[60:61], v11 offset:22528
  s_waitcnt lgkmcnt(11)
  v_mfma_f32_16x16x32_bf16 v[32:35], v[208:211], v[224:227], v[32:35]
  ds_read_b64_tr_b16 v[62:63], v11 offset:22784
  v_mfma_f32_16x16x32_bf16 v[40:43], v[212:215], v[224:227], v[40:43]
  ds_read_b64_tr_b16 v[64:65], v13 offset:30720
  v_mfma_f32_16x16x32_bf16 v[44:47], v[212:215], v[228:231], v[44:47]
  ds_read_b64_tr_b16 v[66:67], v13 offset:30976
  v_mfma_f32_16x16x32_bf16 v[36:39], v[208:211], v[228:231], v[36:39]
  ds_read_b64_tr_b16 v[68:69], v11 offset:30720
  s_waitcnt lgkmcnt(11)
  v_mfma_f32_16x16x32_bf16 v[32:35], v[120:123], v[232:235], v[32:35]
  ds_read_b64_tr_b16 v[70:71], v11 offset:30976
  v_mfma_f32_16x16x32_bf16 v[40:43], v[124:127], v[232:235], v[40:43]
  v_mfma_f32_16x16x32_bf16 v[44:47], v[124:127], v[236:239], v[44:47]
  v_mfma_f32_16x16x32_bf16 v[36:39], v[120:123], v[236:239], v[36:39]
  s_waitcnt lgkmcnt(8)
  v_mfma_f32_16x16x32_bf16 v[32:35], v[152:155], v[48:51], v[32:35]
  v_mfma_f32_16x16x32_bf16 v[40:43], v[156:159], v[48:51], v[40:43]
  v_mfma_f32_16x16x32_bf16 v[44:47], v[156:159], v[52:55], v[44:47]
  v_mfma_f32_16x16x32_bf16 v[36:39], v[152:155], v[52:55], v[36:39]
  s_waitcnt lgkmcnt(4)
  v_mfma_f32_16x16x32_bf16 v[32:35], v[184:187], v[56:59], v[32:35]
  v_mfma_f32_16x16x32_bf16 v[40:43], v[188:191], v[56:59], v[40:43]
  v_mfma_f32_16x16x32_bf16 v[44:47], v[188:191], v[60:63], v[44:47]
  v_mfma_f32_16x16x32_bf16 v[36:39], v[184:187], v[60:63], v[36:39]
  s_waitcnt lgkmcnt(0)
  v_mfma_f32_16x16x32_bf16 v[32:35], v[216:219], v[64:67], v[32:35]
  v_mfma_f32_16x16x32_bf16 v[40:43], v[220:223], v[64:67], v[40:43]
  v_mfma_f32_16x16x32_bf16 v[44:47], v[220:223], v[68:71], v[44:47]
  v_mfma_f32_16x16x32_bf16 v[36:39], v[216:219], v[68:71], v[36:39]
  s_nop 5
  v_mul_f32 v32, v32, v40
  v_mul_f32 v33, v33, v41
  v_mul_f32 v34, v34, v42
  v_mul_f32 v35, v35, v43
  v_mul_f32 v36, v36, v44
  v_mul_f32 v37, v37, v45
  v_mul_f32 v38, v38, v46
  v_mul_f32 v39, v39, v47
  v_cvt_pk_bf16_f32 v84, v32, v33
  v_cvt_pk_bf16_f32 v85, v34, v35
  v_cvt_pk_bf16_f32 v86, v36, v37
  v_cvt_pk_bf16_f32 v87, v38, v39
  s_nop 0
  v_permlane16_swap_b32 v84, v86
  v_permlane16_swap_b32 v85, v87
  buffer_store_dwordx4 v[80:83], v3, s[60:63], s5 offen sc1
  buffer_store_dwordx4 v[84:87], v3, s[60:63], s5 offen offset:1024 sc1
  s_waitcnt vmcnt(0)
  s_mov_b64 exec, 1
  ds_write_b32 v15, v6
  ds_read_b128 v[8:11], v14
  s_waitcnt lgkmcnt(0)
  v_cmpx_eq_u32 vcc, v6, v8
  v_cmpx_eq_u32 vcc, v6, v9
  v_cmpx_eq_u32 vcc, v6, v10
  v_cmpx_eq_u32 vcc, v6, v11
  s_cbranch_execz hfl
  global_store_dword v5, v6, s[46:47] sc1
hfl:
  s_mov_b64 exec, -1
  s_endpgm
m_main:
  v_lshrrev_b32 v6, 5, v0
  v_mul_u32_u24 v6, 4608, v6
  v_and_b32 v7, 31, v0
  v_lshl_add_u32 v6, v7, 4, v6
  v_add_u32 v6, 131584, v6
  v_bfe_u32 v7, v0, 1, 2
  v_lshrrev_b32 v40, 7, v0
  v_lshl_add_u32 v7, v40, 2, v7
  v_mul_u32_u24 v7, 4160, v7
  v_and_b32 v40, 1, v0
  v_lshl_add_u32 v7, v40, 4, v7
  v_add_u32 v7, 98304, v7
  v_cmp_gt_u32 vcc, 64, v0
  v_mov_b32 v36, 0
  v_mov_b32 v37, 0
  v_mov_b32 v38, 0
  v_mov_b32 v39, 0
  v_cndmask_b32 v6, v7, v6, vcc
  ds_write_b128 v6, v[36:39]
  s_and_b32 s50, s2, 3
  s_lshr_b32 s15, s2, 5
  s_bfe_u32 s34, s2, 0x20003
  s_and_b32 s12, s2, 4
  s_add_u32 s12, s12, s34
  s_mul_i32 s13, s50, 7
  s_add_u32 s13, s13, s15
  s_mov_b32 s49, s15
  s_and_b32 s5, s15, 3
  s_cmp_eq_u32 s5, 3
  s_cselect_b32 s5, 4, 0
  s_xor_b32 s15, s15, s5
  s_and_b32 s49, s49, 3
  s_cmp_eq_u32 s49, 1
  s_mov_b32 s5, 0x10327654
  s_cselect_b32 s5, 0x32107654, s5
  s_cmp_eq_u32 s49, 2
  s_cselect_b32 s5, 0x54763210, s5
  s_cmp_eq_u32 s49, 3
  s_cselect_b32 s49, 0x76543210, s5
  s_mul_i32 s5, s50, 0x22222222
  s_add_u32 s5, s5, 0x10101010
  s_cmp_eq_u32 s15, 3
  s_cselect_b32 s49, s5, s49
  s_cselect_b32 s13, 0, s13
  s_lshl_b32 s14, s12, 2
  s_add_u32 s14, s14, s50
  s_lshr_b32 s7, s10, 1
  s_mul_i32 s8, s7, 45312
  v_and_b32 v7, 127, v0
  v_lshl_add_u32 v240, v7, 2, s8
  v_add_u32 v241, 5664, v240
  v_add_u32 v242, 11328, v240
  v_add_u32 v243, 16992, v240
  v_add_u32 v244, 22656, v240
  v_add_u32 v245, 28320, v240
  v_add_u32 v246, 33984, v240
  v_add_u32 v247, 39648, v240
  v_and_b32 v2, 15, v0
  v_bfe_u32 v3, v0, 4, 2
  s_mul_i32 s9, s7, 16640
  s_add_u32 s9, s9, 98304
  v_lshl_add_u32 v4, v3, 4, s8
  v_and_b32 v26, 7, v2
  v_lshrrev_b32 v15, 3, v2
  v_mul_u32_u24 v16, 5664, v26
  v_lshl_add_u32 v16, v15, 9, v16
  v_add_u32 v16, v16, v4
  v_and_b32 v6, 3, v2
  v_bfe_u32 v7, v2, 2, 1
  v_lshl_add_u32 v20, v2, 5, s9
  v_lshl_add_u32 v21, v3, 9, v20
  v_add_u32 v21, 2048, v21
  v_lshrrev_b32 v22, 1, v3
  v_lshl_add_u32 v20, v22, 9, v20
  v_and_b32 v22, 1, v3
  v_lshl_add_u32 v20, v22, 4, v20
  s_bitcmp1_b32 s10, 0
  s_cbranch_scc1 m_adrY
  v_lshl_add_u32 v26, v7, 3, v6
  v_subrev_u32 v27, 1, v6
  v_max_i32 v27, 0, v27
  v_lshl_add_u32 v27, v7, 2, v27
  v_cmp_eq_u32 vcc, 1, v15
  v_lshlrev_b32 v28, 1, v15
  v_sub_u32 v28, 4, v28
  v_cndmask_b32 v26, v26, v27, vcc
  v_and_b32 v27, 3, v26
  v_lshl_add_u32 v27, v15, 2, v27
  v_lshrrev_b32 v29, 2, v26
  v_add_u32 v29, 2, v29
  v_mul_u32_u24 v17, 5664, v27
  v_lshl_add_u32 v17, v29, 9, v17
  v_add_u32 v17, v17, v4
  v_add_u32 v26, v26, v28
  v_and_b32 v27, 3, v26
  v_lshl_add_u32 v27, v15, 2, v27
  v_lshrrev_b32 v29, 2, v26
  v_add_u32 v29, 2, v29
  v_mul_u32_u24 v18, 5664, v27
  v_lshl_add_u32 v18, v29, 9, v18
  v_add_u32 v18, v18, v4
  v_add_u32 v26, v26, v28
  v_and_b32 v27, 3, v26
  v_lshl_add_u32 v27, v15, 2, v27
  v_lshrrev_b32 v29, 2, v26
  v_add_u32 v29, 2, v29
  v_mul_u32_u24 v19, 5664, v27
  v_lshl_add_u32 v19, v29, 9, v19
  v_add_u32 v19, v19, v4
  s_branch m_adrJ
m_adrY:
  v_lshl_add_u32 v26, v7, 1, v6
  v_and_b32 v27, 3, v26
  v_lshl_add_u32 v27, v15, 2, v27
  v_lshrrev_b32 v29, 2, v26
  v_lshlrev_b32 v28, 1, v15
  v_sub_u32 v29, v29, v28
  v_add_u32 v29, 7, v29
  v_mul_u32_u24 v17, 5664, v27
  v_lshl_add_u32 v17, v29, 9, v17
  v_add_u32 v17, v17, v4
  v_lshl_add_u32 v27, v15, 2, v6
  v_sub_u32 v29, v7, v28
  v_add_u32 v29, 9, v29
  v_mul_u32_u24 v18, 5664, v27
  v_lshl_add_u32 v18, v29, 9, v18
  v_add_u32 v18, v18, v4
  v_add_u32 v20, 1024, v20
m_adrJ:
  v_add_u32 v4, 1, v2
  v_and_b32 v5, 3, v4
  v_mul_u32_u24 v5, 4160, v5
  v_lshrrev_b32 v4, 2, v4
  v_lshl_add_u32 v5, v4, 3, v5
  v_lshlrev_b32 v4, 4, v3
  v_sub_u32 v5, v5, v4
  s_and_b32 s8, s10, 1
  s_lshl_b32 s8, s8, 8
  s_add_u32 s9, s9, s8
  s_add_u32 s9, s9, 48
  v_add_u32 v23, s9, v5
  s_mul_i32 s9, s7, 4608
  s_add_u32 s9, s9, 131872
  s_sub_u32 s9, s9, s8
  v_lshl_add_u32 v24, v2, 5, v4
  v_add_u32 v24, s9, v24
  v_lshrrev_b32 v4, 1, v3
  v_bfe_u32 v5, v2, 2, 1
  v_xor_b32 v4, v4, v5
  v_lshl_add_u32 v4, v2, 1, v4
  v_and_b32 v5, 1, v3
  v_lshlrev_b32 v5, 3, v5
  v_lshl_add_u32 v25, v4, 4, v5
  s_lshl_b32 s8, s10, 12
  s_add_u32 s8, s8, 140800
  v_add_u32 v25, s8, v25
  s_waitcnt lgkmcnt(0)
  s_lshl_b32 s8, s6, 16
  s_and_b32 s9, s6, 0xffff0000
  s_cmp_ge_u32 s10, 2
  s_cselect_b32 s8, s9, s8
  v_mov_b32 v7, 0x3fb8aa3b
  v_mul_f32 v40, s8, v7
  v_exp_f32 v40, v40
  s_nop 0
  v_cvt_pk_bf16_f32 v40, v40, v40
  v_lshlrev_b32 v40, 16, v40
  s_waitcnt vmcnt(0)
  v_mul_f32 v41, v40, v8
  v_mul_f32 v42, v40, v9
  v_mul_f32 v41, v41, v7
  v_mul_f32 v42, 0.15915494, v42
  v_mul_f32 v10, v40, v10
  v_mul_f32 v11, v40, v11
  v_exp_f32 v132, v41
  v_fract_f32 v133, v42
  v_mul_f32 v135, 0x41800000, v41
  v_mul_f32 v136, 0x41800000, v42
  v_exp_f32 v135, v135
  v_fract_f32 v136, v136
  v_mul_f32 v138, 0x43800000, v41
  v_mul_f32 v139, 0x43800000, v42
  v_exp_f32 v138, v138
  v_fract_f32 v139, v139
  v_cos_f32 v44, v133
  v_sin_f32 v45, v133
  v_cos_f32 v74, v136
  v_sin_f32 v75, v136
  v_cos_f32 v86, v139
  v_sin_f32 v87, v139
  v_pk_mul_f32 v[100:101], v[12:13], v[10:11] op_sel:[0,0] op_sel_hi:[1,0]
  v_pk_fma_f32 v[100:101], v[12:13], v[10:11], v[100:101] op_sel:[1,1,0] op_sel_hi:[0,1,1] neg_lo:[1,0,0]
  v_mov_b32 v160, 0x00003f80
  v_mul_f32 v44, v44, v132
  v_mul_f32 v45, v45, v132
  v_mul_f32 v74, v74, v135
  v_mul_f32 v75, v75, v135
  v_mul_f32 v86, v86, v138
  v_mul_f32 v87, v87, v138
  v_cvt_pk_bf16_f32 v161, v100, -v101
  v_pk_mul_f32 v[46:47], v[44:45], v[44:45] op_sel:[0,0] op_sel_hi:[1,0]
  ds_write2st64_b32 v240, v160, v161 offset0:4 offset1:0
  v_pk_mul_f32 v[80:81], v[74:75], v[74:75] op_sel:[0,0] op_sel_hi:[1,0]
  v_pk_mul_f32 v[88:89], v[86:87], v[86:87] op_sel:[0,0] op_sel_hi:[1,0]
  v_pk_mul_f32 v[102:103], v[100:101], v[74:75] op_sel:[0,0] op_sel_hi:[1,0]
  v_pk_mul_f32 v[76:77], v[74:75], v[44:45] op_sel:[0,0] op_sel_hi:[1,0]
  v_pk_fma_f32 v[46:47], v[44:45], v[44:45], v[46:47] op_sel:[1,1,0] op_sel_hi:[0,1,1] neg_lo:[1,0,0]
  v_pk_fma_f32 v[80:81], v[74:75], v[74:75], v[80:81] op_sel:[1,1,0] op_sel_hi:[0,1,1] neg_lo:[1,0,0]
  v_pk_fma_f32 v[88:89], v[86:87], v[86:87], v[88:89] op_sel:[1,1,0] op_sel_hi:[0,1,1] neg_lo:[1,0,0]
  v_pk_fma_f32 v[102:103], v[100:101], v[74:75], v[102:103] op_sel:[1,1,0] op_sel_hi:[0,1,1] neg_lo:[1,0,0]
  v_pk_fma_f32 v[76:77], v[74:75], v[44:45], v[76:77] op_sel:[1,1,0] op_sel_hi:[0,1,1] neg_lo:[1,0,0]
  v_cvt_pk_bf16_f32 v162, v44, v45
  v_cvt_pk_bf16_f32 v163, v74, v75
  v_cvt_pk_bf16_f32 v164, v86, v87
  v_pk_mul_f32 v[50:51], v[46:47], v[46:47] op_sel:[0,0] op_sel_hi:[1,0]
  v_pk_mul_f32 v[82:83], v[80:81], v[80:81] op_sel:[0,0] op_sel_hi:[1,0]
  v_pk_mul_f32 v[92:93], v[88:89], v[88:89] op_sel:[0,0] op_sel_hi:[1,0]
  v_pk_mul_f32 v[48:49], v[46:47], v[44:45] op_sel:[0,0] op_sel_hi:[1,0]
  v_pk_fma_f32 v[50:51], v[46:47], v[46:47], v[50:51] op_sel:[1,1,0] op_sel_hi:[0,1,1] neg_lo:[1,0,0]
  v_pk_fma_f32 v[82:83], v[80:81], v[80:81], v[82:83] op_sel:[1,1,0] op_sel_hi:[0,1,1] neg_lo:[1,0,0]
  v_pk_fma_f32 v[92:93], v[88:89], v[88:89], v[92:93] op_sel:[1,1,0] op_sel_hi:[0,1,1] neg_lo:[1,0,0]
  v_pk_fma_f32 v[48:49], v[46:47], v[44:45], v[48:49] op_sel:[1,1,0] op_sel_hi:[0,1,1] neg_lo:[1,0,0]
  v_cvt_pk_bf16_f32 v165, v76, v77
  v_cvt_pk_bf16_f32 v166, v88, v89
  ds_write2st64_b32 v241, v162, v165 offset0:4 offset1:12
  v_cvt_pk_bf16_f32 v167, v46, v47
  v_cvt_pk_bf16_f32 v168, v102, -v103
  v_pk_mul_f32 v[90:91], v[88:89], v[86:87] op_sel:[0,0] op_sel_hi:[1,0]
  v_pk_mul_f32 v[104:105], v[100:101], v[80:81] op_sel:[0,0] op_sel_hi:[1,0]
  v_pk_mul_f32 v[106:107], v[102:103], v[80:81] op_sel:[0,0] op_sel_hi:[1,0]
  ds_write2st64_b32 v240, v163, v166 offset0:12 offset1:14
  v_pk_mul_f32 v[78:79], v[74:75], v[46:47] op_sel:[0,0] op_sel_hi:[1,0]
  v_pk_fma_f32 v[90:91], v[88:89], v[86:87], v[90:91] op_sel:[1,1,0] op_sel_hi:[0,1,1] neg_lo:[1,0,0]
  v_pk_fma_f32 v[104:105], v[100:101], v[80:81], v[104:105] op_sel:[1,1,0] op_sel_hi:[0,1,1] neg_lo:[1,0,0]
  v_pk_fma_f32 v[106:107], v[102:103], v[80:81], v[106:107] op_sel:[1,1,0] op_sel_hi:[0,1,1] neg_lo:[1,0,0]
  v_pk_fma_f32 v[78:79], v[74:75], v[46:47], v[78:79] op_sel:[1,1,0] op_sel_hi:[0,1,1] neg_lo:[1,0,0]
  v_cvt_pk_bf16_f32 v169, v50, v51
  v_cvt_pk_bf16_f32 v170, v92, v93
  v_cvt_pk_bf16_f32 v171, v48, v49
  ds_write2st64_b32 v240, v169, v170 offset0:6 offset1:18
  v_pk_mul_f32 v[58:59], v[50:51], v[50:51] op_sel:[0,0] op_sel_hi:[1,0]
  v_pk_mul_f32 v[84:85], v[82:83], v[82:83] op_sel:[0,0] op_sel_hi:[1,0]
  v_pk_mul_f32 v[52:53], v[50:51], v[44:45] op_sel:[0,0] op_sel_hi:[1,0]
  v_pk_mul_f32 v[54:55], v[50:51], v[46:47] op_sel:[0,0] op_sel_hi:[1,0]
  v_pk_fma_f32 v[58:59], v[50:51], v[50:51], v[58:59] op_sel:[1,1,0] op_sel_hi:[0,1,1] neg_lo:[1,0,0]
  v_pk_fma_f32 v[84:85], v[82:83], v[82:83], v[84:85] op_sel:[1,1,0] op_sel_hi:[0,1,1] neg_lo:[1,0,0]
  v_pk_fma_f32 v[52:53], v[50:51], v[44:45], v[52:53] op_sel:[1,1,0] op_sel_hi:[0,1,1] neg_lo:[1,0,0]
  v_pk_fma_f32 v[54:55], v[50:51], v[46:47], v[54:55] op_sel:[1,1,0] op_sel_hi:[0,1,1] neg_lo:[1,0,0]
  v_cvt_pk_bf16_f32 v172, v90, v91
  v_cvt_pk_bf16_f32 v173, v104, -v105
  ds_write2st64_b32 v244, v164, v172 offset0:4 offset1:10
  v_cvt_pk_bf16_f32 v174, v106, -v107
  v_cvt_pk_bf16_f32 v175, v78, v79
  v_pk_mul_f32 v[56:57], v[50:51], v[48:49] op_sel:[0,0] op_sel_hi:[1,0]
  v_pk_mul_f32 v[94:95], v[92:93], v[86:87] op_sel:[0,0] op_sel_hi:[1,0]
  v_pk_mul_f32 v[96:97], v[92:93], v[88:89] op_sel:[0,0] op_sel_hi:[1,0]
  ds_write2st64_b32 v242, v167, v173 offset0:4 offset1:0
  v_pk_mul_f32 v[98:99], v[92:93], v[90:91] op_sel:[0,0] op_sel_hi:[1,0]
  v_pk_fma_f32 v[56:57], v[50:51], v[48:49], v[56:57] op_sel:[1,1,0] op_sel_hi:[0,1,1] neg_lo:[1,0,0]
  v_pk_fma_f32 v[94:95], v[92:93], v[86:87], v[94:95] op_sel:[1,1,0] op_sel_hi:[0,1,1] neg_lo:[1,0,0]
  v_pk_fma_f32 v[96:97], v[92:93], v[88:89], v[96:97] op_sel:[1,1,0] op_sel_hi:[0,1,1] neg_lo:[1,0,0]
  v_pk_fma_f32 v[98:99], v[92:93], v[90:91], v[98:99] op_sel:[1,1,0] op_sel_hi:[0,1,1] neg_lo:[1,0,0]
  ds_write2st64_b32 v243, v171, v174 offset0:4 offset1:0
  v_cvt_pk_bf16_f32 v176, v58, v59
  v_cvt_pk_bf16_f32 v177, v52, v53
  v_cvt_pk_bf16_f32 v178, v54, v55
  v_pk_mul_f32 v[108:109], v[100:101], v[82:83] op_sel:[0,0] op_sel_hi:[1,0]
  v_pk_mul_f32 v[110:111], v[102:103], v[82:83] op_sel:[0,0] op_sel_hi:[1,0]
  ds_write2st64_b32 v241, v168, v177 offset0:0 offset1:6
  v_pk_mul_f32 v[112:113], v[104:105], v[82:83] op_sel:[0,0] op_sel_hi:[1,0]
  v_pk_mul_f32 v[114:115], v[106:107], v[82:83] op_sel:[0,0] op_sel_hi:[1,0]
  v_pk_fma_f32 v[108:109], v[100:101], v[82:83], v[108:109] op_sel:[1,1,0] op_sel_hi:[0,1,1] neg_lo:[1,0,0]
  v_pk_fma_f32 v[110:111], v[102:103], v[82:83], v[110:111] op_sel:[1,1,0] op_sel_hi:[0,1,1] neg_lo:[1,0,0]
  v_pk_fma_f32 v[112:113], v[104:105], v[82:83], v[112:113] op_sel:[1,1,0] op_sel_hi:[0,1,1] neg_lo:[1,0,0]
  ds_write2st64_b32 v242, v175, v178 offset0:12 offset1:6
  v_pk_fma_f32 v[114:115], v[106:107], v[82:83], v[114:115] op_sel:[1,1,0] op_sel_hi:[0,1,1] neg_lo:[1,0,0]
  v_cvt_pk_bf16_f32 v179, v56, v57
  v_cvt_pk_bf16_f32 v180, v94, v95
  v_cvt_pk_bf16_f32 v181, v96, v97
  v_cvt_pk_bf16_f32 v182, v98, v99
  ds_write2st64_b32 v240, v176, v180 offset0:8 offset1:20
  v_pk_mul_f32 v[60:61], v[58:59], v[44:45] op_sel:[0,0] op_sel_hi:[1,0]
  v_pk_mul_f32 v[62:63], v[58:59], v[46:47] op_sel:[0,0] op_sel_hi:[1,0]
  v_pk_mul_f32 v[64:65], v[58:59], v[48:49] op_sel:[0,0] op_sel_hi:[1,0]
  v_pk_mul_f32 v[66:67], v[58:59], v[50:51] op_sel:[0,0] op_sel_hi:[1,0]
  v_pk_fma_f32 v[60:61], v[58:59], v[44:45], v[60:61] op_sel:[1,1,0] op_sel_hi:[0,1,1] neg_lo:[1,0,0]
  ds_write2st64_b32 v244, v181, v182 offset0:14 offset1:16
  v_pk_fma_f32 v[62:63], v[58:59], v[46:47], v[62:63] op_sel:[1,1,0] op_sel_hi:[0,1,1] neg_lo:[1,0,0]
  v_pk_fma_f32 v[64:65], v[58:59], v[48:49], v[64:65] op_sel:[1,1,0] op_sel_hi:[0,1,1] neg_lo:[1,0,0]
  v_pk_fma_f32 v[66:67], v[58:59], v[50:51], v[66:67] op_sel:[1,1,0] op_sel_hi:[0,1,1] neg_lo:[1,0,0]
  v_cvt_pk_bf16_f32 v183, v108, -v109
  v_cvt_pk_bf16_f32 v184, v110, -v111
  v_cvt_pk_bf16_f32 v185, v112, -v113
  v_cvt_pk_bf16_f32 v186, v114, -v115
  v_pk_mul_f32 v[68:69], v[58:59], v[52:53] op_sel:[0,0] op_sel_hi:[1,0]
  v_pk_mul_f32 v[70:71], v[58:59], v[54:55] op_sel:[0,0] op_sel_hi:[1,0]
  v_pk_mul_f32 v[72:73], v[58:59], v[56:57] op_sel:[0,0] op_sel_hi:[1,0]
  v_pk_mul_f32 v[132:133], v[86:87], v[46:47] op_sel:[0,0] op_sel_hi:[1,0]
  v_pk_fma_f32 v[68:69], v[58:59], v[52:53], v[68:69] op_sel:[1,1,0] op_sel_hi:[0,1,1] neg_lo:[1,0,0]
  v_pk_fma_f32 v[70:71], v[58:59], v[54:55], v[70:71] op_sel:[1,1,0] op_sel_hi:[0,1,1] neg_lo:[1,0,0]
  v_pk_fma_f32 v[72:73], v[58:59], v[56:57], v[72:73] op_sel:[1,1,0] op_sel_hi:[0,1,1] neg_lo:[1,0,0]
  v_pk_fma_f32 v[132:133], v[86:87], v[46:47], v[132:133] op_sel:[1,1,0] op_sel_hi:[0,1,1] neg_lo:[1,0,0]
  v_cvt_pk_bf16_f32 v187, v60, v61
  v_cvt_pk_bf16_f32 v188, v62, v63
  v_cvt_pk_bf16_f32 v189, v64, v65
  v_cvt_pk_bf16_f32 v190, v66, v67
  ds_write2st64_b32 v243, v179, v189 offset0:6 offset1:8
  v_pk_mul_f32 v[134:135], v[86:87], v[50:51] op_sel:[0,0] op_sel_hi:[1,0]
  v_pk_mul_f32 v[136:137], v[86:87], v[54:55] op_sel:[0,0] op_sel_hi:[1,0]
  v_pk_mul_f32 v[138:139], v[86:87], v[58:59] op_sel:[0,0] op_sel_hi:[1,0]
  v_pk_mul_f32 v[146:147], v[86:87], v[74:75] op_sel:[0,0] op_sel_hi:[1,0]
  v_pk_fma_f32 v[134:135], v[86:87], v[50:51], v[134:135] op_sel:[1,1,0] op_sel_hi:[0,1,1] neg_lo:[1,0,0]
  v_pk_fma_f32 v[136:137], v[86:87], v[54:55], v[136:137] op_sel:[1,1,0] op_sel_hi:[0,1,1] neg_lo:[1,0,0]
  v_pk_fma_f32 v[138:139], v[86:87], v[58:59], v[138:139] op_sel:[1,1,0] op_sel_hi:[0,1,1] neg_lo:[1,0,0]
  v_pk_fma_f32 v[146:147], v[86:87], v[74:75], v[146:147] op_sel:[1,1,0] op_sel_hi:[0,1,1] neg_lo:[1,0,0]
  v_cvt_pk_bf16_f32 v191, v68, v69
  v_cvt_pk_bf16_f32 v192, v70, v71
  ds_write2st64_b32 v241, v187, v191 offset0:8 offset1:10
  v_cvt_pk_bf16_f32 v193, v72, v73
  v_cvt_pk_bf16_f32 v194, v132, v133
  v_pk_mul_f32 v[148:149], v[86:87], v[78:79] op_sel:[0,0] op_sel_hi:[1,0]
  v_pk_mul_f32 v[116:117], v[100:101], v[84:85] op_sel:[0,0] op_sel_hi:[1,0]
  v_pk_mul_f32 v[118:119], v[102:103], v[84:85] op_sel:[0,0] op_sel_hi:[1,0]
  ds_write2st64_b32 v242, v188, v192 offset0:8 offset1:10
  v_pk_mul_f32 v[120:121], v[104:105], v[84:85] op_sel:[0,0] op_sel_hi:[1,0]
  v_pk_fma_f32 v[148:149], v[86:87], v[78:79], v[148:149] op_sel:[1,1,0] op_sel_hi:[0,1,1] neg_lo:[1,0,0]
  v_pk_fma_f32 v[116:117], v[100:101], v[84:85], v[116:117] op_sel:[1,1,0] op_sel_hi:[0,1,1] neg_lo:[1,0,0]
  v_pk_fma_f32 v[118:119], v[102:103], v[84:85], v[118:119] op_sel:[1,1,0] op_sel_hi:[0,1,1] neg_lo:[1,0,0]
  v_pk_fma_f32 v[120:121], v[104:105], v[84:85], v[120:121] op_sel:[1,1,0] op_sel_hi:[0,1,1] neg_lo:[1,0,0]
  ds_write2st64_b32 v245, v184, v194 offset0:0 offset1:4
  v_cvt_pk_bf16_f32 v195, v134, v135
  v_cvt_pk_bf16_f32 v196, v136, v137
  v_cvt_pk_bf16_f32 v197, v138, v139
  v_cvt_pk_bf16_f32 v198, v146, v147
  v_pk_mul_f32 v[122:123], v[106:107], v[84:85] op_sel:[0,0] op_sel_hi:[1,0]
  ds_write2st64_b32 v246, v185, v195 offset0:0 offset1:4
  v_pk_mul_f32 v[124:125], v[108:109], v[84:85] op_sel:[0,0] op_sel_hi:[1,0]
  v_pk_mul_f32 v[126:127], v[110:111], v[84:85] op_sel:[0,0] op_sel_hi:[1,0]
  v_pk_mul_f32 v[128:129], v[112:113], v[84:85] op_sel:[0,0] op_sel_hi:[1,0]
  v_pk_fma_f32 v[122:123], v[106:107], v[84:85], v[122:123] op_sel:[1,1,0] op_sel_hi:[0,1,1] neg_lo:[1,0,0]
  v_pk_fma_f32 v[124:125], v[108:109], v[84:85], v[124:125] op_sel:[1,1,0] op_sel_hi:[0,1,1] neg_lo:[1,0,0]
  ds_write2st64_b32 v247, v186, v196 offset0:0 offset1:4
  v_pk_fma_f32 v[126:127], v[110:111], v[84:85], v[126:127] op_sel:[1,1,0] op_sel_hi:[0,1,1] neg_lo:[1,0,0]
  v_pk_fma_f32 v[128:129], v[112:113], v[84:85], v[128:129] op_sel:[1,1,0] op_sel_hi:[0,1,1] neg_lo:[1,0,0]
  v_cvt_pk_bf16_f32 v199, v148, v149
  v_cvt_pk_bf16_f32 v200, v116, -v117
  v_cvt_pk_bf16_f32 v201, v118, -v119
  ds_write2st64_b32 v244, v183, v197 offset0:0 offset1:6
  v_cvt_pk_bf16_f32 v202, v120, -v121
  v_pk_mul_f32 v[130:131], v[114:115], v[84:85] op_sel:[0,0] op_sel_hi:[1,0]
  v_pk_mul_f32 v[140:141], v[86:87], v[62:63] op_sel:[0,0] op_sel_hi:[1,0]
  v_pk_mul_f32 v[142:143], v[86:87], v[66:67] op_sel:[0,0] op_sel_hi:[1,0]
  v_pk_mul_f32 v[144:145], v[86:87], v[70:71] op_sel:[0,0] op_sel_hi:[1,0]
  ds_write2st64_b32 v240, v190, v200 offset0:10 offset1:2
  v_pk_fma_f32 v[130:131], v[114:115], v[84:85], v[130:131] op_sel:[1,1,0] op_sel_hi:[0,1,1] neg_lo:[1,0,0]
  v_pk_fma_f32 v[140:141], v[86:87], v[62:63], v[140:141] op_sel:[1,1,0] op_sel_hi:[0,1,1] neg_lo:[1,0,0]
  v_pk_fma_f32 v[142:143], v[86:87], v[66:67], v[142:143] op_sel:[1,1,0] op_sel_hi:[0,1,1] neg_lo:[1,0,0]
  v_pk_fma_f32 v[144:145], v[86:87], v[70:71], v[144:145] op_sel:[1,1,0] op_sel_hi:[0,1,1] neg_lo:[1,0,0]
  v_cvt_pk_bf16_f32 v203, v122, -v123
  v_cvt_pk_bf16_f32 v204, v124, -v125
  ds_write2st64_b32 v243, v193, v203 offset0:10 offset1:2
  v_cvt_pk_bf16_f32 v205, v126, -v127
  v_cvt_pk_bf16_f32 v206, v128, -v129
  v_pk_mul_f32 v[100:101], v[88:89], v[50:51] op_sel:[0,0] op_sel_hi:[1,0]
  v_pk_mul_f32 v[102:103], v[88:89], v[58:59] op_sel:[0,0] op_sel_hi:[1,0]
  v_pk_mul_f32 v[104:105], v[88:89], v[66:67] op_sel:[0,0] op_sel_hi:[1,0]
  ds_write2st64_b32 v244, v198, v204 offset0:8 offset1:2
  v_pk_mul_f32 v[106:107], v[88:89], v[74:75] op_sel:[0,0] op_sel_hi:[1,0]
  v_pk_fma_f32 v[100:101], v[88:89], v[50:51], v[100:101] op_sel:[1,1,0] op_sel_hi:[0,1,1] neg_lo:[1,0,0]
  v_pk_fma_f32 v[102:103], v[88:89], v[58:59], v[102:103] op_sel:[1,1,0] op_sel_hi:[0,1,1] neg_lo:[1,0,0]
  v_pk_fma_f32 v[104:105], v[88:89], v[66:67], v[104:105] op_sel:[1,1,0] op_sel_hi:[0,1,1] neg_lo:[1,0,0]
  v_pk_fma_f32 v[106:107], v[88:89], v[74:75], v[106:107] op_sel:[1,1,0] op_sel_hi:[0,1,1] neg_lo:[1,0,0]
  ds_write2st64_b32 v245, v199, v205 offset0:8 offset1:2
  v_cvt_pk_bf16_f32 v207, v130, -v131
  v_cvt_pk_bf16_f32 v208, v140, v141
  v_cvt_pk_bf16_f32 v209, v142, v143
  v_cvt_pk_bf16_f32 v210, v144, v145
  v_pk_mul_f32 v[108:109], v[90:91], v[50:51] op_sel:[0,0] op_sel_hi:[1,0]
  ds_write2st64_b32 v246, v206, v209 offset0:2 offset1:6
  v_pk_mul_f32 v[110:111], v[90:91], v[58:59] op_sel:[0,0] op_sel_hi:[1,0]
  v_pk_mul_f32 v[112:113], v[90:91], v[66:67] op_sel:[0,0] op_sel_hi:[1,0]
  v_pk_mul_f32 v[114:115], v[90:91], v[74:75] op_sel:[0,0] op_sel_hi:[1,0]
  v_pk_fma_f32 v[108:109], v[90:91], v[50:51], v[108:109] op_sel:[1,1,0] op_sel_hi:[0,1,1] neg_lo:[1,0,0]
  v_pk_fma_f32 v[110:111], v[90:91], v[58:59], v[110:111] op_sel:[1,1,0] op_sel_hi:[0,1,1] neg_lo:[1,0,0]
  ds_write2st64_b32 v247, v207, v210 offset0:2 offset1:6
  v_pk_fma_f32 v[112:113], v[90:91], v[66:67], v[112:113] op_sel:[1,1,0] op_sel_hi:[0,1,1] neg_lo:[1,0,0]
  v_pk_fma_f32 v[114:115], v[90:91], v[74:75], v[114:115] op_sel:[1,1,0] op_sel_hi:[0,1,1] neg_lo:[1,0,0]
  v_cvt_pk_bf16_f32 v211, v100, v101
  v_cvt_pk_bf16_f32 v212, v102, v103
  v_cvt_pk_bf16_f32 v213, v104, v105
  ds_write2st64_b32 v241, v201, v211 offset0:2 offset1:14
  v_cvt_pk_bf16_f32 v214, v106, v107
  v_pk_mul_f32 v[116:117], v[92:93], v[58:59] op_sel:[0,0] op_sel_hi:[1,0]
  v_pk_mul_f32 v[118:119], v[92:93], v[74:75] op_sel:[0,0] op_sel_hi:[1,0]
  v_pk_mul_f32 v[120:121], v[94:95], v[58:59] op_sel:[0,0] op_sel_hi:[1,0]
  v_pk_mul_f32 v[122:123], v[94:95], v[74:75] op_sel:[0,0] op_sel_hi:[1,0]
  ds_write2st64_b32 v242, v202, v212 offset0:2 offset1:14
  v_pk_fma_f32 v[116:117], v[92:93], v[58:59], v[116:117] op_sel:[1,1,0] op_sel_hi:[0,1,1] neg_lo:[1,0,0]
  v_pk_fma_f32 v[118:119], v[92:93], v[74:75], v[118:119] op_sel:[1,1,0] op_sel_hi:[0,1,1] neg_lo:[1,0,0]
  v_pk_fma_f32 v[120:121], v[94:95], v[58:59], v[120:121] op_sel:[1,1,0] op_sel_hi:[0,1,1] neg_lo:[1,0,0]
  v_pk_fma_f32 v[122:123], v[94:95], v[74:75], v[122:123] op_sel:[1,1,0] op_sel_hi:[0,1,1] neg_lo:[1,0,0]
  v_cvt_pk_bf16_f32 v215, v108, v109
  v_cvt_pk_bf16_f32 v216, v110, v111
  ds_write2st64_b32 v245, v208, v215 offset0:6 offset1:10
  v_cvt_pk_bf16_f32 v217, v112, v113
  v_cvt_pk_bf16_f32 v218, v114, v115
  v_pk_mul_f32 v[124:125], v[96:97], v[58:59] op_sel:[0,0] op_sel_hi:[1,0]
  v_pk_mul_f32 v[126:127], v[96:97], v[74:75] op_sel:[0,0] op_sel_hi:[1,0]
  v_pk_mul_f32 v[128:129], v[98:99], v[58:59] op_sel:[0,0] op_sel_hi:[1,0]
  v_pk_mul_f32 v[130:131], v[98:99], v[74:75] op_sel:[0,0] op_sel_hi:[1,0]
  v_pk_fma_f32 v[124:125], v[96:97], v[58:59], v[124:125] op_sel:[1,1,0] op_sel_hi:[0,1,1] neg_lo:[1,0,0]
  v_pk_fma_f32 v[126:127], v[96:97], v[74:75], v[126:127] op_sel:[1,1,0] op_sel_hi:[0,1,1] neg_lo:[1,0,0]
  v_pk_fma_f32 v[128:129], v[98:99], v[58:59], v[128:129] op_sel:[1,1,0] op_sel_hi:[0,1,1] neg_lo:[1,0,0]
  v_pk_fma_f32 v[130:131], v[98:99], v[74:75], v[130:131] op_sel:[1,1,0] op_sel_hi:[0,1,1] neg_lo:[1,0,0]
  v_cvt_pk_bf16_f32 v219, v116, v117
  v_cvt_pk_bf16_f32 v220, v118, v119
  v_cvt_pk_bf16_f32 v221, v120, v121
  v_cvt_pk_bf16_f32 v222, v122, v123
  ds_write2st64_b32 v241, v219, v221 offset0:18 offset1:20
  v_cvt_pk_bf16_f32 v223, v124, v125
  v_cvt_pk_bf16_f32 v224, v126, v127
  v_cvt_pk_bf16_f32 v225, v128, v129
  v_cvt_pk_bf16_f32 v226, v130, v131
  ds_write2st64_b32 v242, v220, v222 offset0:18 offset1:20
  ds_write2st64_b32 v246, v216, v224 offset0:10 offset1:14
  ds_write2st64_b32 v245, v223, v225 offset0:14 offset1:16
  ds_write_b32 v243, v213 offset:3584
  ds_write_b32 v240, v214 offset:4096
  ds_write_b32 v247, v217 offset:2560
  ds_write_b32 v244, v218 offset:3072
  ds_write_b32 v246, v226 offset:4096
  s_lshl_b32 s8, s7, 2
  s_add_u32 s8, s8, 163780
  v_mov_b32 v26, s8
  v_mov_b32 v27, 1
  s_mov_b64 exec, 1
  ds_add_u32 v26, v27
  s_mov_b64 exec, -1
  s_mov_b32 s97, 0
lsp6:
  ds_read_b32 v27, v26 offset:0
  s_add_u32 s97, s97, 1
  s_waitcnt lgkmcnt(0)
  v_readfirstlane_b32 s96, v27
  s_cmp_ge_u32 s97, 4194304
  s_cbranch_scc1 lsx6
  s_cmp_lt_u32 s96, 2
  s_cbranch_scc1 lsp6
lsx6:
  s_bitcmp1_b32 s10, 0
  s_cbranch_scc1 m_waveY
  ds_read_b128 v[44:47], v16 offset:0
  ds_read_b128 v[76:79], v17 offset:0
  ds_read_b128 v[80:83], v18 offset:0
  ds_read_b128 v[84:87], v19 offset:0
  ds_read_b128 v[48:51], v16 offset:64
  ds_read_b128 v[88:91], v17 offset:64
  ds_read_b128 v[92:95], v18 offset:64
  ds_read_b128 v[96:99], v19 offset:64
  ds_read_b128 v[52:55], v16 offset:128
  ds_read_b128 v[100:103], v17 offset:128
  ds_read_b128 v[104:107], v18 offset:128
  ds_read_b128 v[108:111], v19 offset:128
  s_waitcnt lgkmcnt(8)
  v_mfma_f32_16x16x32_bf16 v[172:175], v[76:79], v[44:47], 0
  ds_read_b128 v[56:59], v16 offset:192
  ds_read_b128 v[112:115], v17 offset:192
  v_mfma_f32_16x16x32_bf16 v[176:179], v[80:83], v[44:47], 0
  ds_read_b128 v[116:119], v18 offset:192
  v_mfma_f32_16x16x32_bf16 v[180:183], v[84:87], v[44:47], 0
  ds_read_b128 v[120:123], v19 offset:192
  s_waitcnt lgkmcnt(8)
  v_mfma_f32_16x16x32_bf16 v[172:175], v[88:91], v[48:51], v[172:175]
  ds_read_b128 v[60:63], v16 offset:256
  ds_read_b128 v[124:127], v17 offset:256
  v_mfma_f32_16x16x32_bf16 v[176:179], v[92:95], v[48:51], v[176:179]
  ds_read_b128 v[128:131], v18 offset:256
  v_mfma_f32_16x16x32_bf16 v[180:183], v[96:99], v[48:51], v[180:183]
  ds_read_b128 v[132:135], v19 offset:256
  s_waitcnt lgkmcnt(8)
  v_mfma_f32_16x16x32_bf16 v[172:175], v[100:103], v[52:55], v[172:175]
  ds_read_b128 v[64:67], v16 offset:320
  ds_read_b128 v[136:139], v17 offset:320
  v_mfma_f32_16x16x32_bf16 v[176:179], v[104:107], v[52:55], v[176:179]
  ds_read_b128 v[140:143], v18 offset:320
  v_mfma_f32_16x16x32_bf16 v[180:183], v[108:111], v[52:55], v[180:183]
  ds_read_b128 v[144:147], v19 offset:320
  s_waitcnt lgkmcnt(8)
  v_mfma_f32_16x16x32_bf16 v[172:175], v[112:115], v[56:59], v[172:175]
  ds_read_b128 v[68:71], v16 offset:384
  ds_read_b128 v[148:151], v17 offset:384
  v_mfma_f32_16x16x32_bf16 v[176:179], v[116:119], v[56:59], v[176:179]
  ds_read_b128 v[152:155], v18 offset:384
  v_mfma_f32_16x16x32_bf16 v[180:183], v[120:123], v[56:59], v[180:183]
  ds_read_b128 v[156:159], v19 offset:384
  s_waitcnt lgkmcnt(8)
  v_mfma_f32_16x16x32_bf16 v[172:175], v[124:127], v[60:63], v[172:175]
  ds_read_b128 v[72:75], v16 offset:448
  ds_read_b128 v[160:163], v17 offset:448
  v_mfma_f32_16x16x32_bf16 v[176:179], v[128:131], v[60:63], v[176:179]
  ds_read_b128 v[164:167], v18 offset:448
  v_mfma_f32_16x16x32_bf16 v[180:183], v[132:135], v[60:63], v[180:183]
  ds_read_b128 v[168:171], v19 offset:448
  s_waitcnt lgkmcnt(8)
  v_mfma_f32_16x16x32_bf16 v[172:175], v[136:139], v[64:67], v[172:175]
  v_mfma_f32_16x16x32_bf16 v[176:179], v[140:143], v[64:67], v[176:179]
  v_mfma_f32_16x16x32_bf16 v[180:183], v[144:147], v[64:67], v[180:183]
  s_waitcnt lgkmcnt(4)
  v_mfma_f32_16x16x32_bf16 v[172:175], v[148:151], v[68:71], v[172:175]
  v_mfma_f32_16x16x32_bf16 v[176:179], v[152:155], v[68:71], v[176:179]
  v_mfma_f32_16x16x32_bf16 v[180:183], v[156:159], v[68:71], v[180:183]
  s_waitcnt lgkmcnt(0)
  v_mfma_f32_16x16x32_bf16 v[172:175], v[160:163], v[72:75], v[172:175]
  v_mfma_f32_16x16x32_bf16 v[176:179], v[164:167], v[72:75], v[176:179]
  v_mfma_f32_16x16x32_bf16 v[180:183], v[168:171], v[72:75], v[180:183]
  s_nop 7
  s_mov_b32 exec_lo, 0x80000000
  s_mov_b32 exec_hi, 0
  v_mov_b32 v181, v180
  s_mov_b32 exec_lo, 0
  s_mov_b32 exec_hi, 0x80000000
  v_mov_b32 v182, v181
  s_mov_b64 exec, -1
  v_cvt_pk_bf16_f32 v76, v172, v173
  v_cvt_pk_bf16_f32 v77, v174, v175
  v_cvt_pk_bf16_f32 v78, v176, v177
  v_cvt_pk_bf16_f32 v79, v178, v179
  ds_write_b128 v20, v[76:79] offset:32
  v_cvt_pk_bf16_f32 v80, v173, v174
  v_cvt_pk_bf16_f32 v81, v175, v176
  v_cvt_pk_bf16_f32 v82, v177, v178
  v_cvt_pk_bf16_f32 v83, v179, v180
  ds_write_b128 v20, v[80:83] offset:4192
  v_cvt_pk_bf16_f32 v84, v174, v175
  v_cvt_pk_bf16_f32 v85, v176, v177
  v_cvt_pk_bf16_f32 v86, v178, v179
  v_cvt_pk_bf16_f32 v87, v180, v181
  ds_write_b128 v20, v[84:87] offset:8352
  v_cvt_pk_bf16_f32 v88, v175, v176
  v_cvt_pk_bf16_f32 v89, v177, v178
  v_cvt_pk_bf16_f32 v90, v179, v180
  v_cvt_pk_bf16_f32 v91, v181, v182
  ds_write_b128 v20, v[88:91] offset:12512
  v_cvt_pk_bf16_f32 v13, 0, v172
  s_mov_b64 exec, 1
  ds_write_b32 v20, v13 offset:4188
  ds_write_b32 v20, v76 offset:8348
  ds_write_b32 v20, v13 offset:12504
  ds_write_b32 v20, v80 offset:12508
  s_mov_b64 exec, -1
  s_branch m_join
m_waveY:
  ds_read_b128 v[44:47], v16 offset:0
  ds_read_b128 v[76:79], v17 offset:0
  ds_read_b128 v[80:83], v18 offset:0
  ds_read_b128 v[48:51], v16 offset:64
  ds_read_b128 v[84:87], v17 offset:64
  ds_read_b128 v[88:91], v18 offset:64
  ds_read_b128 v[52:55], v16 offset:128
  ds_read_b128 v[92:95], v17 offset:128
  ds_read_b128 v[96:99], v18 offset:128
  s_waitcnt lgkmcnt(6)
  v_mfma_f32_16x16x32_bf16 v[172:175], v[76:79], v[44:47], 0
  ds_read_b128 v[56:59], v16 offset:192
  ds_read_b128 v[100:103], v17 offset:192
  v_mfma_f32_16x16x32_bf16 v[176:179], v[80:83], v[44:47], 0
  ds_read_b128 v[104:107], v18 offset:192
  s_waitcnt lgkmcnt(6)
  v_mfma_f32_16x16x32_bf16 v[172:175], v[84:87], v[48:51], v[172:175]
  ds_read_b128 v[60:63], v16 offset:256
  ds_read_b128 v[108:111], v17 offset:256
  v_mfma_f32_16x16x32_bf16 v[176:179], v[88:91], v[48:51], v[176:179]
  ds_read_b128 v[112:115], v18 offset:256
  s_waitcnt lgkmcnt(6)
  v_mfma_f32_16x16x32_bf16 v[172:175], v[92:95], v[52:55], v[172:175]
  ds_read_b128 v[64:67], v16 offset:320
  ds_read_b128 v[116:119], v17 offset:320
  v_mfma_f32_16x16x32_bf16 v[176:179], v[96:99], v[52:55], v[176:179]
  ds_read_b128 v[120:123], v18 offset:320
  s_waitcnt lgkmcnt(6)
  v_mfma_f32_16x16x32_bf16 v[172:175], v[100:103], v[56:59], v[172:175]
  ds_read_b128 v[68:71], v16 offset:384
  ds_read_b128 v[124:127], v17 offset:384
  v_mfma_f32_16x16x32_bf16 v[176:179], v[104:107], v[56:59], v[176:179]
  ds_read_b128 v[128:131], v18 offset:384
  s_waitcnt lgkmcnt(6)
  v_mfma_f32_16x16x32_bf16 v[172:175], v[108:111], v[60:63], v[172:175]
  ds_read_b128 v[72:75], v16 offset:448
  ds_read_b128 v[132:135], v17 offset:448
  v_mfma_f32_16x16x32_bf16 v[176:179], v[112:115], v[60:63], v[176:179]
  ds_read_b128 v[136:139], v18 offset:448
  s_waitcnt lgkmcnt(6)
  v_mfma_f32_16x16x32_bf16 v[172:175], v[116:119], v[64:67], v[172:175]
  v_mfma_f32_16x16x32_bf16 v[176:179], v[120:123], v[64:67], v[176:179]
  s_waitcnt lgkmcnt(3)
  v_mfma_f32_16x16x32_bf16 v[172:175], v[124:127], v[68:71], v[172:175]
  v_mfma_f32_16x16x32_bf16 v[176:179], v[128:131], v[68:71], v[176:179]
  s_waitcnt lgkmcnt(0)
  v_mfma_f32_16x16x32_bf16 v[172:175], v[132:135], v[72:75], v[172:175]
  v_mfma_f32_16x16x32_bf16 v[176:179], v[136:139], v[72:75], v[176:179]
  s_nop 6
  v_cvt_pk_bf16_f32 v76, v172, v172
  v_cvt_pk_bf16_f32 v77, v172, v173
  v_cvt_pk_bf16_f32 v78, v173, v173
  v_cvt_pk_bf16_f32 v79, v174, v174
  ds_write_b128 v20, v[76:79] offset:32
  v_cvt_pk_bf16_f32 v80, v172, v172
  v_cvt_pk_bf16_f32 v81, v173, v173
  v_cvt_pk_bf16_f32 v82, v173, v174
  v_cvt_pk_bf16_f32 v83, v174, v174
  ds_write_b128 v20, v[80:83] offset:4192
  v_cvt_pk_bf16_f32 v84, v172, v173
  v_cvt_pk_bf16_f32 v85, v173, v173
  v_cvt_pk_bf16_f32 v86, v174, v174
  v_cvt_pk_bf16_f32 v87, v174, v174
  ds_write_b128 v20, v[84:87] offset:8352
  v_cvt_pk_bf16_f32 v88, v173, v173
  v_cvt_pk_bf16_f32 v89, v173, v174
  v_cvt_pk_bf16_f32 v90, v174, v174
  v_cvt_pk_bf16_f32 v91, v174, v174
  ds_write_b128 v20, v[88:91] offset:12512
  v_cvt_pk_bf16_f32 v92, v176, v176
  v_cvt_pk_bf16_f32 v93, v176, v176
  v_cvt_pk_bf16_f32 v94, v176, v177
  v_cvt_pk_bf16_f32 v95, v177, v177
  ds_write_b128 v21, v[92:95] offset:32
  v_cvt_pk_bf16_f32 v96, v176, v176
  v_cvt_pk_bf16_f32 v97, v176, v176
  v_cvt_pk_bf16_f32 v98, v177, v177
  v_cvt_pk_bf16_f32 v99, v177, v177
  ds_write_b128 v21, v[96:99] offset:4192
  v_cvt_pk_bf16_f32 v100, v176, v176
  v_cvt_pk_bf16_f32 v101, v176, v177
  v_cvt_pk_bf16_f32 v102, v177, v177
  v_cvt_pk_bf16_f32 v103, v177, v177
  ds_write_b128 v21, v[100:103] offset:8352
  v_cvt_pk_bf16_f32 v104, v176, v176
  v_cvt_pk_bf16_f32 v105, v177, v177
  v_cvt_pk_bf16_f32 v106, v177, v177
  v_cvt_pk_bf16_f32 v107, v177, v177
  ds_write_b128 v21, v[104:107] offset:12512
  v_cvt_pk_bf16_f32 v108, v177, v177
  v_cvt_pk_bf16_f32 v109, v177, v177
  v_cvt_pk_bf16_f32 v110, v178, v178
  v_cvt_pk_bf16_f32 v111, v178, v178
  ds_write_b128 v21, v[108:111] offset:48
  v_cvt_pk_bf16_f32 v112, v177, v177
  v_cvt_pk_bf16_f32 v113, v177, v178
  v_cvt_pk_bf16_f32 v114, v178, v178
  v_cvt_pk_bf16_f32 v115, v178, v178
  ds_write_b128 v21, v[112:115] offset:4208
  v_cvt_pk_bf16_f32 v116, v177, v177
  v_cvt_pk_bf16_f32 v117, v178, v178
  v_cvt_pk_bf16_f32 v118, v178, v178
  v_cvt_pk_bf16_f32 v119, v178, v178
  ds_write_b128 v21, v[116:119] offset:8368
  v_cvt_pk_bf16_f32 v120, v177, v178
  v_cvt_pk_bf16_f32 v121, v178, v178
  v_cvt_pk_bf16_f32 v122, v178, v178
  v_cvt_pk_bf16_f32 v123, v178, v178
  ds_write_b128 v21, v[120:123] offset:12528
m_join:
  v_mov_b32 v27, 1
  s_mov_b64 exec, 1
  ds_add_u32 v26, v27
  s_mov_b64 exec, -1
  s_mov_b32 s97, 0
lsp7:
  ds_read_b32 v27, v26 offset:0
  s_add_u32 s97, s97, 1
  s_waitcnt lgkmcnt(0)
  v_readfirstlane_b32 s96, v27
  s_cmp_ge_u32 s97, 4194304
  s_cbranch_scc1 lsx7
  s_cmp_lt_u32 s96, 4
  s_cbranch_scc1 lsp7
lsx7:
  ds_read_b64 v[60:61], v23 offset:0
  ds_read_b64 v[62:63], v23 offset:8
  ds_read_b64 v[64:65], v23 offset:512
  ds_read_b64 v[66:67], v23 offset:520
  ds_read_b64 v[68:69], v23 offset:1024
  ds_read_b64 v[70:71], v23 offset:1032
  ds_read_b64 v[72:73], v23 offset:1536
  ds_read_b64 v[74:75], v23 offset:1544
  ds_read_b64 v[92:93], v23 offset:64
  ds_read_b64 v[94:95], v23 offset:72
  ds_read_b64 v[96:97], v23 offset:576
  ds_read_b64 v[98:99], v23 offset:584
  ds_read_b64 v[100:101], v23 offset:1088
  ds_read_b64 v[102:103], v23 offset:1096
  ds_read_b64 v[104:105], v23 offset:1600
  ds_read_b64 v[106:107], v23 offset:1608
  ds_read_b64 v[124:125], v23 offset:128
  ds_read_b64 v[126:127], v23 offset:136
  ds_read_b64 v[128:129], v23 offset:640
  ds_read_b64 v[130:131], v23 offset:648
  ds_read_b64 v[132:133], v23 offset:1152
  ds_read_b64 v[134:135], v23 offset:1160
  ds_read_b64 v[136:137], v23 offset:1664
  ds_read_b64 v[138:139], v23 offset:1672
  ds_read_b64 v[156:157], v23 offset:192
  ds_read_b64 v[158:159], v23 offset:200
  ds_read_b64 v[160:161], v23 offset:704
  ds_read_b64 v[162:163], v23 offset:712
  ds_read_b64 v[164:165], v23 offset:1216
  ds_read_b64 v[166:167], v23 offset:1224
  ds_read_b64 v[168:169], v23 offset:1728
  ds_read_b64 v[170:171], v23 offset:1736
  s_waitcnt lgkmcnt(0)
  s_barrier
  ds_read_b128 v[76:79], v24 offset:192
  ds_read_b128 v[80:83], v24 offset:704
  ds_read_b128 v[84:87], v24 offset:1216
  ds_read_b128 v[88:91], v24 offset:1728
  ds_read_b128 v[108:111], v24 offset:128
  ds_read_b128 v[112:115], v24 offset:640
  s_waitcnt lgkmcnt(5)
  v_mfma_f32_16x16x32_bf16 v[28:31], v[60:63], v[76:79], 0
  ds_read_b128 v[116:119], v24 offset:1152
  s_waitcnt lgkmcnt(5)
  v_mfma_f32_16x16x32_bf16 v[32:35], v[60:63], v[80:83], 0
  ds_read_b128 v[120:123], v24 offset:1664
  v_mfma_f32_16x16x32_bf16 v[32:35], v[64:67], v[76:79], v[32:35]
  ds_read_b128 v[140:143], v24 offset:64
  v_mfma_f32_16x16x32_bf16 v[36:39], v[64:67], v[80:83], 0
  ds_read_b128 v[144:147], v24 offset:576
  s_waitcnt lgkmcnt(7)
  v_mfma_f32_16x16x32_bf16 v[36:39], v[60:63], v[84:87], v[36:39]
  ds_read_b128 v[148:151], v24 offset:1088
  v_mfma_f32_16x16x32_bf16 v[40:43], v[64:67], v[84:87], 0
  ds_read_b128 v[152:155], v24 offset:1600
  v_mfma_f32_16x16x32_bf16 v[36:39], v[68:71], v[76:79], v[36:39]
  ds_read_b128 v[172:175], v24 offset:0
  v_mfma_f32_16x16x32_bf16 v[40:43], v[68:71], v[80:83], v[40:43]
  ds_read_b128 v[176:179], v24 offset:512
  s_waitcnt lgkmcnt(10)
  v_mfma_f32_16x16x32_bf16 v[40:43], v[60:63], v[88:91], v[40:43]
  ds_read_b128 v[180:183], v24 offset:1024
  v_mfma_f32_16x16x32_bf16 v[40:43], v[72:75], v[76:79], v[40:43]
  ds_read_b128 v[184:187], v24 offset:1536
  s_waitcnt lgkmcnt(11)
  v_mfma_f32_16x16x32_bf16 v[28:31], v[92:95], v[108:111], v[28:31]
  ds_read_b64 v[188:189], v23 offset:2048
  s_waitcnt lgkmcnt(11)
  v_mfma_f32_16x16x32_bf16 v[32:35], v[92:95], v[112:115], v[32:35]
  ds_read_b64 v[190:191], v23 offset:2056
  v_mfma_f32_16x16x32_bf16 v[32:35], v[96:99], v[108:111], v[32:35]
  ds_read_b128 v[204:207], v24 offset:2240
  v_mfma_f32_16x16x32_bf16 v[36:39], v[96:99], v[112:115], v[36:39]
  ds_read_b64 v[192:193], v23 offset:2560
  s_waitcnt lgkmcnt(13)
  v_mfma_f32_16x16x32_bf16 v[36:39], v[92:95], v[116:119], v[36:39]
  ds_read_b64 v[194:195], v23 offset:2568
  v_mfma_f32_16x16x32_bf16 v[40:43], v[96:99], v[116:119], v[40:43]
  v_mfma_f32_16x16x32_bf16 v[36:39], v[100:103], v[108:111], v[36:39]
  v_mfma_f32_16x16x32_bf16 v[40:43], v[100:103], v[112:115], v[40:43]
  s_waitcnt lgkmcnt(13)
  v_mfma_f32_16x16x32_bf16 v[40:43], v[92:95], v[120:123], v[40:43]
  ds_read_b128 v[208:211], v24 offset:2752
  v_mfma_f32_16x16x32_bf16 v[40:43], v[104:107], v[108:111], v[40:43]
  s_waitcnt lgkmcnt(13)
  v_mfma_f32_16x16x32_bf16 v[28:31], v[124:127], v[140:143], v[28:31]
  ds_read_b64 v[196:197], v23 offset:3072
  s_waitcnt lgkmcnt(13)
  v_mfma_f32_16x16x32_bf16 v[32:35], v[124:127], v[144:147], v[32:35]
  ds_read_b64 v[198:199], v23 offset:3080
  v_mfma_f32_16x16x32_bf16 v[32:35], v[128:131], v[140:143], v[32:35]
  v_mfma_f32_16x16x32_bf16 v[36:39], v[128:131], v[144:147], v[36:39]
  s_waitcnt lgkmcnt(13)
  v_mfma_f32_16x16x32_bf16 v[36:39], v[124:127], v[148:151], v[36:39]
  ds_read_b128 v[212:215], v24 offset:3264
  v_mfma_f32_16x16x32_bf16 v[40:43], v[128:131], v[148:151], v[40:43]
  v_mfma_f32_16x16x32_bf16 v[36:39], v[132:135], v[140:143], v[36:39]
  v_mfma_f32_16x16x32_bf16 v[40:43], v[132:135], v[144:147], v[40:43]
  s_waitcnt lgkmcnt(13)
  v_mfma_f32_16x16x32_bf16 v[40:43], v[124:127], v[152:155], v[40:43]
  ds_read_b64 v[200:201], v23 offset:3584
  v_mfma_f32_16x16x32_bf16 v[40:43], v[136:139], v[140:143], v[40:43]
  s_waitcnt lgkmcnt(13)
  v_mfma_f32_16x16x32_bf16 v[28:31], v[156:159], v[172:175], v[28:31]
  ds_read_b64 v[202:203], v23 offset:3592
  s_waitcnt lgkmcnt(13)
  v_mfma_f32_16x16x32_bf16 v[32:35], v[156:159], v[176:179], v[32:35]
  ds_read_b128 v[216:219], v24 offset:3776
  v_mfma_f32_16x16x32_bf16 v[32:35], v[160:163], v[172:175], v[32:35]
  v_mfma_f32_16x16x32_bf16 v[36:39], v[160:163], v[176:179], v[36:39]
  s_waitcnt lgkmcnt(13)
  v_mfma_f32_16x16x32_bf16 v[36:39], v[156:159], v[180:183], v[36:39]
  v_cvt_pk_bf16_f32 v8, v28, v29
  v_cvt_pk_bf16_f32 v9, v30, v31
  v_mfma_f32_16x16x32_bf16 v[40:43], v[160:163], v[180:183], v[40:43]
  ds_write_b64 v25, v[8:9] offset:0
  v_mfma_f32_16x16x32_bf16 v[36:39], v[164:167], v[172:175], v[36:39]
  v_cvt_pk_bf16_f32 v10, v32, v33
  v_cvt_pk_bf16_f32 v11, v34, v35
  v_mfma_f32_16x16x32_bf16 v[40:43], v[164:167], v[176:179], v[40:43]
  ds_write_b64 v25, v[10:11] offset:512
  s_waitcnt lgkmcnt(14)
  v_mfma_f32_16x16x32_bf16 v[40:43], v[156:159], v[184:187], v[40:43]
  v_mfma_f32_16x16x32_bf16 v[40:43], v[168:171], v[172:175], v[40:43]
  v_mfma_f32_16x16x32_bf16 v[44:47], v[64:67], v[88:91], 0
  v_cvt_pk_bf16_f32 v12, v36, v37
  v_cvt_pk_bf16_f32 v13, v38, v39
  v_mfma_f32_16x16x32_bf16 v[44:47], v[68:71], v[84:87], v[44:47]
  ds_write_b64 v25, v[12:13] offset:1024
  v_mfma_f32_16x16x32_bf16 v[48:51], v[68:71], v[88:91], 0
  v_mfma_f32_16x16x32_bf16 v[44:47], v[72:75], v[80:83], v[44:47]
  s_nop 0
  v_cvt_pk_bf16_f32 v14, v40, v41
  v_cvt_pk_bf16_f32 v15, v42, v43
  v_mfma_f32_16x16x32_bf16 v[48:51], v[72:75], v[84:87], v[48:51]
  ds_write_b64 v25, v[14:15] offset:1536
  v_mfma_f32_16x16x32_bf16 v[52:55], v[72:75], v[88:91], 0
  v_mfma_f32_16x16x32_bf16 v[44:47], v[96:99], v[120:123], v[44:47]
  v_mfma_f32_16x16x32_bf16 v[44:47], v[100:103], v[116:119], v[44:47]
  v_mfma_f32_16x16x32_bf16 v[48:51], v[100:103], v[120:123], v[48:51]
  v_mfma_f32_16x16x32_bf16 v[44:47], v[104:107], v[112:115], v[44:47]
  v_mfma_f32_16x16x32_bf16 v[48:51], v[104:107], v[116:119], v[48:51]
  v_mfma_f32_16x16x32_bf16 v[52:55], v[104:107], v[120:123], v[52:55]
  v_mfma_f32_16x16x32_bf16 v[44:47], v[128:131], v[152:155], v[44:47]
  v_mfma_f32_16x16x32_bf16 v[44:47], v[132:135], v[148:151], v[44:47]
  v_mfma_f32_16x16x32_bf16 v[48:51], v[132:135], v[152:155], v[48:51]
  v_mfma_f32_16x16x32_bf16 v[44:47], v[136:139], v[144:147], v[44:47]
  v_mfma_f32_16x16x32_bf16 v[48:51], v[136:139], v[148:151], v[48:51]
  v_mfma_f32_16x16x32_bf16 v[52:55], v[136:139], v[152:155], v[52:55]
  v_mfma_f32_16x16x32_bf16 v[44:47], v[160:163], v[184:187], v[44:47]
  v_mfma_f32_16x16x32_bf16 v[44:47], v[164:167], v[180:183], v[44:47]
  v_mfma_f32_16x16x32_bf16 v[48:51], v[164:167], v[184:187], v[48:51]
  v_mfma_f32_16x16x32_bf16 v[44:47], v[168:171], v[176:179], v[44:47]
  v_mfma_f32_16x16x32_bf16 v[48:51], v[168:171], v[180:183], v[48:51]
  v_mfma_f32_16x16x32_bf16 v[52:55], v[168:171], v[184:187], v[52:55]
  s_waitcnt lgkmcnt(13)
  v_mfma_f32_16x16x32_bf16 v[44:47], v[60:63], v[204:207], v[44:47]
  ds_read_b64 v[220:221], v23 offset:2112
  v_mfma_f32_16x16x32_bf16 v[48:51], v[64:67], v[204:207], v[48:51]
  v_mfma_f32_16x16x32_bf16 v[52:55], v[68:71], v[204:207], v[52:55]
  v_mfma_f32_16x16x32_bf16 v[56:59], v[72:75], v[204:207], 0
  v_mfma_f32_16x16x32_bf16 v[44:47], v[188:191], v[76:79], v[44:47]
  v_mfma_f32_16x16x32_bf16 v[48:51], v[188:191], v[80:83], v[48:51]
  v_mfma_f32_16x16x32_bf16 v[52:55], v[188:191], v[84:87], v[52:55]
  v_mfma_f32_16x16x32_bf16 v[56:59], v[188:191], v[88:91], v[56:59]
  s_waitcnt lgkmcnt(11)
  v_mfma_f32_16x16x32_bf16 v[48:51], v[60:63], v[208:211], v[48:51]
  ds_read_b64 v[222:223], v23 offset:2120
  v_mfma_f32_16x16x32_bf16 v[52:55], v[64:67], v[208:211], v[52:55]
  ds_read_b128 v[236:239], v24 offset:2176
  v_mfma_f32_16x16x32_bf16 v[56:59], v[68:71], v[208:211], v[56:59]
  ds_read_b64 v[224:225], v23 offset:2624
  v_mfma_f32_16x16x32_bf16 v[48:51], v[192:195], v[76:79], v[48:51]
  v_mfma_f32_16x16x32_bf16 v[52:55], v[192:195], v[80:83], v[52:55]
  v_mfma_f32_16x16x32_bf16 v[56:59], v[192:195], v[84:87], v[56:59]
  s_waitcnt lgkmcnt(11)
  v_mfma_f32_16x16x32_bf16 v[52:55], v[60:63], v[212:215], v[52:55]
  ds_read_b64 v[226:227], v23 offset:2632
  v_mfma_f32_16x16x32_bf16 v[56:59], v[64:67], v[212:215], v[56:59]
  ds_read_b128 v[240:243], v24 offset:2688
  v_mfma_f32_16x16x32_bf16 v[52:55], v[196:199], v[76:79], v[52:55]
  ds_read_b64 v[228:229], v23 offset:3136
  v_mfma_f32_16x16x32_bf16 v[56:59], v[196:199], v[80:83], v[56:59]
  s_waitcnt lgkmcnt(11)
  v_mfma_f32_16x16x32_bf16 v[56:59], v[60:63], v[216:219], v[56:59]
  ds_read_b64 v[230:231], v23 offset:3144
  v_mfma_f32_16x16x32_bf16 v[56:59], v[200:203], v[76:79], v[56:59]
  ds_read_b128 v[244:247], v24 offset:3200
  s_waitcnt lgkmcnt(6)
  v_mfma_f32_16x16x32_bf16 v[44:47], v[92:95], v[236:239], v[44:47]
  ds_read_b64 v[232:233], v23 offset:3648
  v_mfma_f32_16x16x32_bf16 v[48:51], v[96:99], v[236:239], v[48:51]
  ds_read_b64 v[234:235], v23 offset:3656
  v_mfma_f32_16x16x32_bf16 v[52:55], v[100:103], v[236:239], v[52:55]
  ds_read_b128 v[248:251], v24 offset:3712
  v_mfma_f32_16x16x32_bf16 v[56:59], v[104:107], v[236:239], v[56:59]
  ds_read_b64 v[188:189], v23 offset:2176
  v_mfma_f32_16x16x32_bf16 v[44:47], v[220:223], v[108:111], v[44:47]
  ds_read_b64 v[190:191], v23 offset:2184
  v_mfma_f32_16x16x32_bf16 v[48:51], v[220:223], v[112:115], v[48:51]
  ds_read_b128 v[204:207], v24 offset:2112
  v_mfma_f32_16x16x32_bf16 v[52:55], v[220:223], v[116:119], v[52:55]
  ds_read_b64 v[192:193], v23 offset:2688
  v_mfma_f32_16x16x32_bf16 v[56:59], v[220:223], v[120:123], v[56:59]
  ds_read_b64 v[194:195], v23 offset:2696
  s_waitcnt lgkmcnt(11)
  v_mfma_f32_16x16x32_bf16 v[48:51], v[92:95], v[240:243], v[48:51]
  ds_read_b128 v[208:211], v24 offset:2624
  v_mfma_f32_16x16x32_bf16 v[52:55], v[96:99], v[240:243], v[52:55]
  ds_read_b64 v[196:197], v23 offset:3200
  v_mfma_f32_16x16x32_bf16 v[56:59], v[100:103], v[240:243], v[56:59]
  ds_read_b64 v[198:199], v23 offset:3208
  v_mfma_f32_16x16x32_bf16 v[48:51], v[224:227], v[108:111], v[48:51]
  v_mfma_f32_16x16x32_bf16 v[52:55], v[224:227], v[112:115], v[52:55]
  v_mfma_f32_16x16x32_bf16 v[56:59], v[224:227], v[116:119], v[56:59]
  s_waitcnt lgkmcnt(11)
  v_mfma_f32_16x16x32_bf16 v[52:55], v[92:95], v[244:247], v[52:55]
  ds_read_b128 v[212:215], v24 offset:3136
  v_mfma_f32_16x16x32_bf16 v[56:59], v[96:99], v[244:247], v[56:59]
  ds_read_b64 v[200:201], v23 offset:3712
  v_mfma_f32_16x16x32_bf16 v[52:55], v[228:231], v[108:111], v[52:55]
  ds_read_b64 v[202:203], v23 offset:3720
  v_mfma_f32_16x16x32_bf16 v[56:59], v[228:231], v[112:115], v[56:59]
  s_waitcnt lgkmcnt(11)
  v_mfma_f32_16x16x32_bf16 v[56:59], v[92:95], v[248:251], v[56:59]
  ds_read_b128 v[216:219], v24 offset:3648
  v_mfma_f32_16x16x32_bf16 v[56:59], v[232:235], v[108:111], v[56:59]
  ds_read_b64 v[220:221], v23 offset:2240
  s_waitcnt lgkmcnt(10)
  v_mfma_f32_16x16x32_bf16 v[44:47], v[124:127], v[204:207], v[44:47]
  ds_read_b64 v[222:223], v23 offset:2248
  v_mfma_f32_16x16x32_bf16 v[48:51], v[128:131], v[204:207], v[48:51]
  ds_read_b128 v[236:239], v24 offset:2048
  v_mfma_f32_16x16x32_bf16 v[52:55], v[132:135], v[204:207], v[52:55]
  ds_read_b64 v[224:225], v23 offset:2752
  v_mfma_f32_16x16x32_bf16 v[56:59], v[136:139], v[204:207], v[56:59]
  ds_read_b64 v[226:227], v23 offset:2760
  v_mfma_f32_16x16x32_bf16 v[44:47], v[188:191], v[140:143], v[44:47]
  v_mfma_f32_16x16x32_bf16 v[48:51], v[188:191], v[144:147], v[48:51]
  v_mfma_f32_16x16x32_bf16 v[52:55], v[188:191], v[148:151], v[52:55]
  v_mfma_f32_16x16x32_bf16 v[56:59], v[188:191], v[152:155], v[56:59]
  s_waitcnt lgkmcnt(11)
  v_mfma_f32_16x16x32_bf16 v[48:51], v[124:127], v[208:211], v[48:51]
  ds_read_b128 v[240:243], v24 offset:2560
  v_mfma_f32_16x16x32_bf16 v[52:55], v[128:131], v[208:211], v[52:55]
  ds_read_b64 v[228:229], v23 offset:3264
  v_mfma_f32_16x16x32_bf16 v[56:59], v[132:135], v[208:211], v[56:59]
  ds_read_b64 v[230:231], v23 offset:3272
  v_mfma_f32_16x16x32_bf16 v[48:51], v[192:195], v[140:143], v[48:51]
  v_mfma_f32_16x16x32_bf16 v[52:55], v[192:195], v[144:147], v[52:55]
  v_mfma_f32_16x16x32_bf16 v[56:59], v[192:195], v[148:151], v[56:59]
  s_waitcnt lgkmcnt(11)
  v_mfma_f32_16x16x32_bf16 v[52:55], v[124:127], v[212:215], v[52:55]
  ds_read_b128 v[244:247], v24 offset:3072
  v_mfma_f32_16x16x32_bf16 v[56:59], v[128:131], v[212:215], v[56:59]
  ds_read_b64 v[232:233], v23 offset:3776
  v_mfma_f32_16x16x32_bf16 v[52:55], v[196:199], v[140:143], v[52:55]
  ds_read_b64 v[234:235], v23 offset:3784
  v_mfma_f32_16x16x32_bf16 v[56:59], v[196:199], v[144:147], v[56:59]
  s_waitcnt lgkmcnt(11)
  v_mfma_f32_16x16x32_bf16 v[56:59], v[124:127], v[216:219], v[56:59]
  ds_read_b128 v[248:251], v24 offset:3584
  v_mfma_f32_16x16x32_bf16 v[56:59], v[200:203], v[140:143], v[56:59]
  s_waitcnt lgkmcnt(9)
  v_mfma_f32_16x16x32_bf16 v[44:47], v[156:159], v[236:239], v[44:47]
  v_mfma_f32_16x16x32_bf16 v[44:47], v[220:223], v[172:175], v[44:47]
  s_waitcnt lgkmcnt(6)
  v_mfma_f32_16x16x32_bf16 v[48:51], v[156:159], v[240:243], v[48:51]
  v_mfma_f32_16x16x32_bf16 v[48:51], v[160:163], v[236:239], v[48:51]
  v_mfma_f32_16x16x32_bf16 v[48:51], v[220:223], v[176:179], v[48:51]
  v_mfma_f32_16x16x32_bf16 v[48:51], v[224:227], v[172:175], v[48:51]
  s_nop 2
  v_cvt_pk_bf16_f32 v8, v44, v45
  v_cvt_pk_bf16_f32 v9, v46, v47
  s_waitcnt lgkmcnt(3)
  v_mfma_f32_16x16x32_bf16 v[52:55], v[156:159], v[244:247], v[52:55]
  ds_write_b64 v25, v[8:9] offset:2048
  v_mfma_f32_16x16x32_bf16 v[52:55], v[160:163], v[240:243], v[52:55]
  v_mfma_f32_16x16x32_bf16 v[52:55], v[164:167], v[236:239], v[52:55]
  v_mfma_f32_16x16x32_bf16 v[52:55], v[220:223], v[180:183], v[52:55]
  v_cvt_pk_bf16_f32 v10, v48, v49
  v_cvt_pk_bf16_f32 v11, v50, v51
  v_mfma_f32_16x16x32_bf16 v[52:55], v[224:227], v[176:179], v[52:55]
  ds_write_b64 v25, v[10:11] offset:2560
  v_mfma_f32_16x16x32_bf16 v[52:55], v[228:231], v[172:175], v[52:55]
  s_waitcnt lgkmcnt(2)
  v_mfma_f32_16x16x32_bf16 v[56:59], v[156:159], v[248:251], v[56:59]
  v_mfma_f32_16x16x32_bf16 v[56:59], v[160:163], v[244:247], v[56:59]
  v_mfma_f32_16x16x32_bf16 v[56:59], v[164:167], v[240:243], v[56:59]
  v_mfma_f32_16x16x32_bf16 v[56:59], v[168:171], v[236:239], v[56:59]
  s_nop 2
  v_cvt_pk_bf16_f32 v12, v52, v53
  v_cvt_pk_bf16_f32 v13, v54, v55
  v_mfma_f32_16x16x32_bf16 v[56:59], v[220:223], v[184:187], v[56:59]
  ds_write_b64 v25, v[12:13] offset:3072
  v_mfma_f32_16x16x32_bf16 v[56:59], v[224:227], v[180:183], v[56:59]
  v_mfma_f32_16x16x32_bf16 v[56:59], v[228:231], v[176:179], v[56:59]
  v_mfma_f32_16x16x32_bf16 v[56:59], v[232:235], v[172:175], v[56:59]
  s_nop 7
  v_cvt_pk_bf16_f32 v14, v56, v57
  v_cvt_pk_bf16_f32 v15, v58, v59
  ds_write_b64 v25, v[14:15] offset:3584
  s_waitcnt lgkmcnt(0)
  s_barrier
  s_mul_i32 s48, s48, 0x9e3779b1
  s_add_u32 s48, s48, 0x7f4a7c15
  s_mov_b32 s51, 0x4051632
  s_mov_b32 s35, 0x3322000
  s_cmp_eq_u32 s50, 1
  s_cselect_b32 s51, 0x5140632, s51
  s_cselect_b32 s35, 0x3322111, s35
  s_cmp_eq_u32 s50, 2
  s_cselect_b32 s51, 0x6235410, s51
  s_cselect_b32 s35, 0x3320000, s35
  s_cmp_eq_u32 s50, 3
  s_cselect_b32 s51, 0x3625410, s51
  s_cselect_b32 s35, 0x3221111, s35
  s_lshl_b32 s8, s34, 11
  s_bfe_u32 s6, s51, 0x40000
  s_lshl_b32 s64, s6, 13
  s_or_b32 s64, s64, s8
  s_xor_b32 s65, s64, 2048
  s_xor_b32 s66, s64, 4096
  s_xor_b32 s67, s64, 6144
  s_bfe_u32 s6, s51, 0x40004
  s_lshl_b32 s68, s6, 13
  s_or_b32 s68, s68, s8
  s_xor_b32 s69, s68, 2048
  s_xor_b32 s70, s68, 4096
  s_xor_b32 s71, s68, 6144
  s_bfe_u32 s6, s51, 0x40008
  s_lshl_b32 s72, s6, 13
  s_or_b32 s72, s72, s8
  s_xor_b32 s73, s72, 2048
  s_xor_b32 s74, s72, 4096
  s_xor_b32 s75, s72, 6144
  s_bfe_u32 s6, s51, 0x4000c
  s_lshl_b32 s76, s6, 13
  s_or_b32 s76, s76, s8
  s_xor_b32 s77, s76, 2048
  s_xor_b32 s78, s76, 4096
  s_xor_b32 s79, s76, 6144
  s_bfe_u32 s6, s51, 0x40010
  s_lshl_b32 s80, s6, 13
  s_or_b32 s80, s80, s8
  s_xor_b32 s81, s80, 2048
  s_xor_b32 s82, s80, 4096
  s_xor_b32 s83, s80, 6144
  s_bfe_u32 s6, s51, 0x40014
  s_lshl_b32 s84, s6, 13
  s_or_b32 s84, s84, s8
  s_xor_b32 s85, s84, 2048
  s_xor_b32 s86, s84, 4096
  s_xor_b32 s87, s84, 6144
  s_bfe_u32 s6, s51, 0x40018
  s_lshl_b32 s88, s6, 13
  s_or_b32 s88, s88, s8
  s_xor_b32 s89, s88, 2048
  s_xor_b32 s90, s88, 4096
  s_xor_b32 s91, s88, 6144
  s_mul_i32 s5, s12, 262144
  s_add_u32 s5, s5, 0x380000
  s_add_u32 s52, s46, s5
  s_addc_u32 s53, s47, 0
  s_and_b32 s53, s53, 0xffff
  s_mov_b32 s54, 0x40000
  s_mov_b32 s55, 0x00020000
  s_mul_i32 s5, s11, 458752
  s_lshl_b32 s6, s15, 7
  s_add_u32 s5, s5, s6
  s_add_u32 s56, s40, s5
  s_addc_u32 s57, s41, 0
  s_and_b32 s57, s57, 0xffff
  s_mov_b32 s58, 457856
  s_mov_b32 s59, 0x00020000
  s_mul_i32 s6, s14, 112
  s_mul_i32 s5, s11, 28
  s_add_u32 s6, s6, s5
  s_lshl_b32 s6, s6, 11
  s_add_u32 s6, s6, 0x680000
  s_add_u32 s60, s46, s6
  s_addc_u32 s61, s47, 0
  s_and_b32 s61, s61, 0xffff
  s_mov_b32 s62, 0xe000
  s_mov_b32 s63, 0x00020000
  s_add_u32 s16, s11, s34
  s_and_b32 s16, s16, 3
  s_lshl_b32 s17, s16, 13
  s_barrier
  v_and_b32 v2, 63, v0
  s_lshl_b32 s18, s11, 13
  v_lshlrev_b32 v3, 4, v2
  v_and_b32 v1, 32, v2
  v_xor_b32 v1, v1, v3
  v_lshrrev_b32 v5, 3, v2
  v_bfe_u32 v6, v2, 4, 1
  v_lshlrev_b32 v6, 2, v6
  v_and_b32 v4, 7, v2
  v_xor_b32 v4, v4, v6
  v_lshlrev_b32 v4, 4, v4
  v_lshl_add_u32 v4, v5, 10, v4
  v_bfe_u32 v5, v2, 2, 2
  v_lshrrev_b32 v6, 5, v2
  v_lshl_add_u32 v6, v6, 3, v5
  v_lshlrev_b32 v8, 7, v6
  v_lshrrev_b32 v5, 1, v5
  s_and_b32 s5, s11, 1
  v_xor_b32 v5, s5, v5
  v_lshl_add_u32 v8, v5, 6, v8
  v_and_b32 v5, 1, v2
  v_lshl_add_u32 v8, v5, 5, v8
  v_bfe_u32 v5, v2, 4, 1
  v_lshl_add_u32 v8, v5, 4, v8
  v_bfe_u32 v5, v2, 1, 1
  v_lshl_add_u32 v8, v5, 3, v8
  v_add_u32 v8, s18, v8
  v_xor_b32 v9, 64, v8
  v_add_u32 v12, 98304, v8
  v_add_u32 v13, 98304, v9
  s_lshr_b32 s5, s11, 1
  s_lshl_b32 s5, s5, 10
  v_add_u32 v10, s5, v3
  v_xor_b32 v11, 1024, v10
  s_lshr_b32 s5, s12, 1
  s_lshl_b32 s5, s5, 12
  s_lshl_b32 s6, s16, 10
  s_add_u32 s5, s5, s6
  s_add_u32 s5, s5, 0x4000
  v_add_u32 v5, s5, v3
  s_mul_i32 s5, s12, 28
  s_mul_i32 s6, s11, 7
  s_add_u32 s5, s5, s6
  s_lshl_b32 s22, s5, 7
  s_add_u32 s22, s22, 0x20000
  s_bfe_u32 s5, s51, 0x40000
  s_bfe_u32 s6, s35, 0x40000
  s_lshl_b32 s5, s5, 7
  s_lshl_b32 s6, s6, 15
  s_add_u32 s5, s5, s6
  s_add_u32 s24, s5, s22
  s_bfe_u32 s5, s51, 0x40004
  s_bfe_u32 s6, s35, 0x40004
  s_lshl_b32 s5, s5, 7
  s_lshl_b32 s6, s6, 15
  s_add_u32 s5, s5, s6
  s_add_u32 s25, s5, s22
  s_bfe_u32 s5, s51, 0x40008
  s_bfe_u32 s6, s35, 0x40008
  s_lshl_b32 s5, s5, 7
  s_lshl_b32 s6, s6, 15
  s_add_u32 s5, s5, s6
  s_add_u32 s26, s5, s22
  s_bfe_u32 s5, s51, 0x4000c
  s_bfe_u32 s6, s35, 0x4000c
  s_lshl_b32 s5, s5, 7
  s_lshl_b32 s6, s6, 15
  s_add_u32 s5, s5, s6
  s_add_u32 s27, s5, s22
  s_bfe_u32 s5, s51, 0x40010
  s_bfe_u32 s6, s35, 0x40010
  s_lshl_b32 s5, s5, 7
  s_lshl_b32 s6, s6, 15
  s_add_u32 s5, s5, s6
  s_add_u32 s28, s5, s22
  s_bfe_u32 s5, s51, 0x40014
  s_bfe_u32 s6, s35, 0x40014
  s_lshl_b32 s5, s5, 7
  s_lshl_b32 s6, s6, 15
  s_add_u32 s5, s5, s6
  s_add_u32 s29, s5, s22
  s_bfe_u32 s5, s51, 0x40018
  s_bfe_u32 s6, s35, 0x40018
  s_lshl_b32 s5, s5, 7
  s_lshl_b32 s6, s6, 15
  s_add_u32 s5, s5, s6
  s_add_u32 s30, s5, s22
  s_barrier
  s_lshl_b32 s5, s64, 3
  s_add_u32 m0, s18, 131072
  s_add_u32 s6, s5, 7168
  buffer_load_dwordx4 v4, s[56:59], s5 offen lds
  buffer_load_dwordx4 v4, s[56:59], s6 offen offset:1024 lds
  s_lshl_b32 s5, s65, 3
  s_add_u32 m0, s18, 133120
  s_add_u32 s6, s5, 7168
  buffer_load_dwordx4 v4, s[56:59], s5 offen lds
  buffer_load_dwordx4 v4, s[56:59], s6 offen offset:1024 lds
  s_lshl_b32 s5, s66, 3
  s_add_u32 m0, s18, 135168
  s_add_u32 s6, s5, 7168
  buffer_load_dwordx4 v4, s[56:59], s5 offen lds
  buffer_load_dwordx4 v4, s[56:59], s6 offen offset:1024 lds
  s_lshl_b32 s5, s67, 3
  s_add_u32 m0, s18, 137216
  s_add_u32 s6, s5, 7168
  buffer_load_dwordx4 v4, s[56:59], s5 offen lds
  buffer_load_dwordx4 v4, s[56:59], s6 offen offset:1024 lds
  s_and_b32 s5, s49, 7
  s_mul_i32 s5, s5, 32768
  s_add_u32 s5, s5, s17
  v_and_b32 v7, 31, v2
  v_lshlrev_b32 v7, 8, v7
  s_and_b32 s6, s15, 1
  s_lshl_b32 s6, s6, 7
  s_add_u32 s5, s5, s6
  buffer_load_dword v7, v7, s[52:55], s5 offen sc1
  s_mov_b64 s[98:99], exec
  s_mov_b32 s97, 0
  s_sleep 12
poll8:
  global_load_dword v6, v5, s[46:47] sc1
  s_add_u32 s97, s97, 1
  s_waitcnt vmcnt(0)
  v_cmp_ne_u32 vcc, s48, v6
  s_nop 0
  s_and_b64 exec, exec, vcc
  s_cbranch_execz pollx8
  s_cmp_ge_u32 s97, 524288
  s_cbranch_scc1 pollx8
  s_sleep 2
  s_branch poll8
pollx8:
  s_mov_b64 exec, s[98:99]
m_sk2:
  s_and_b32 s19, s49, 7
  s_mul_i32 s19, s19, 32768
  s_add_u32 s19, s19, s17
  s_lshr_b32 s49, s49, 4
  s_add_u32 s20, s19, 4096
  s_add_u32 m0, s18, 32768
  s_nop 0
  buffer_load_dwordx4 v1, s[52:55], s19 offen offset:0 sc1 lds
  buffer_load_dwordx4 v1, s[52:55], s19 offen offset:1024 sc1 lds
  buffer_load_dwordx4 v1, s[52:55], s19 offen offset:2048 sc1 lds
  buffer_load_dwordx4 v1, s[52:55], s19 offen offset:3072 sc1 lds
  s_add_u32 m0, s18, 36864
  s_nop 0
  buffer_load_dwordx4 v1, s[52:55], s20 offen offset:0 sc1 lds
  buffer_load_dwordx4 v1, s[52:55], s20 offen offset:1024 sc1 lds
  buffer_load_dwordx4 v1, s[52:55], s20 offen offset:2048 sc1 lds
  buffer_load_dwordx4 v1, s[52:55], s20 offen offset:3072 sc1 lds
  s_waitcnt vmcnt(6)
  s_barrier
  s_and_b32 s19, s49, 7
  s_mul_i32 s19, s19, 32768
  s_add_u32 s19, s19, s17
  s_lshr_b32 s49, s49, 4
  s_add_u32 s20, s19, 4096
  s_add_u32 m0, s18, 65536
  s_nop 0
  buffer_load_dwordx4 v1, s[52:55], s19 offen offset:0 sc1 lds
  buffer_load_dwordx4 v1, s[52:55], s19 offen offset:1024 sc1 lds
  buffer_load_dwordx4 v1, s[52:55], s19 offen offset:2048 sc1 lds
  s_waitcnt vmcnt(3)
  s_barrier
  s_add_u32 m0, s18, 65536
  s_nop 0
  buffer_load_dwordx4 v1, s[52:55], s19 offen offset:3072 sc1 lds
  s_add_u32 m0, s18, 69632
  s_nop 0
  buffer_load_dwordx4 v1, s[52:55], s20 offen offset:0 sc1 lds
  buffer_load_dwordx4 v1, s[52:55], s20 offen offset:1024 sc1 lds
  buffer_load_dwordx4 v1, s[52:55], s20 offen offset:2048 sc1 lds
  buffer_load_dwordx4 v1, s[52:55], s20 offen offset:3072 sc1 lds
  v_lshrrev_b32 v5, 3, v2
  v_min_u32 v5, 6, v5
  v_lshlrev_b32 v5, 2, v5
  v_lshrrev_b32 v5, v5, s51
  v_and_b32 v5, 15, v5
  v_and_b32 v6, 7, v2
  v_lshl_add_u32 v5, v5, 3, v6
  v_lshl_add_u32 v5, v5, 3, s15
  v_lshlrev_b32 v5, 7, v5
  s_cmp_eq_u32 s15, 3
  s_cbranch_scc1 m_spC
  s_and_b32 s19, s49, 7
  s_mul_i32 s19, s19, 32768
  s_add_u32 s19, s19, s17
  s_lshr_b32 s49, s49, 4
  s_add_u32 s20, s19, 4096
  s_add_u32 m0, s18, 0
  s_nop 0
  buffer_load_dwordx4 v1, s[52:55], s19 offen offset:0 sc1 lds
  buffer_load_dwordx4 v1, s[52:55], s19 offen offset:1024 sc1 lds
  buffer_load_dwordx4 v1, s[52:55], s19 offen offset:2048 sc1 lds
  buffer_load_dwordx4 v1, s[52:55], s19 offen offset:3072 sc1 lds
  s_add_u32 m0, s18, 4096
  s_nop 0
  buffer_load_dwordx4 v1, s[52:55], s20 offen offset:0 sc1 lds
  buffer_load_dwordx4 v1, s[52:55], s20 offen offset:1024 sc1 lds
  buffer_load_dwordx4 v1, s[52:55], s20 offen offset:2048 sc1 lds
  buffer_load_dwordx4 v1, s[52:55], s20 offen offset:3072 sc1 lds
  s_waitcnt vmcnt(8)
  s_barrier
  s_and_b32 s19, s49, 7
  s_mul_i32 s19, s19, 32768
  s_add_u32 s19, s19, s17
  s_lshr_b32 s49, s49, 4
  s_add_u32 s20, s19, 4096
  s_add_u32 m0, s18, 32768
  s_nop 0
  buffer_load_dwordx4 v1, s[52:55], s19 offen offset:0 sc1 lds
  buffer_load_dwordx4 v1, s[52:55], s19 offen offset:1024 sc1 lds
  buffer_load_dwordx4 v1, s[52:55], s19 offen offset:2048 sc1 lds
  buffer_load_dwordx4 v1, s[52:55], s19 offen offset:3072 sc1 lds
  s_add_u32 m0, s18, 36864
  s_nop 0
  buffer_load_dwordx4 v1, s[52:55], s20 offen offset:0 sc1 lds
  buffer_load_dwordx4 v1, s[52:55], s20 offen offset:1024 sc1 lds
  buffer_load_dwordx4 v1, s[52:55], s20 offen offset:2048 sc1 lds
  buffer_load_dwordx4 v1, s[52:55], s20 offen offset:3072 sc1 lds
  s_lshl_b32 s5, s68, 3
  s_add_u32 m0, s18, 98304
  s_add_u32 s6, s5, 7168
  buffer_load_dwordx4 v4, s[56:59], s5 offen lds
  buffer_load_dwordx4 v4, s[56:59], s6 offen offset:1024 lds
  s_lshl_b32 s5, s69, 3
  s_add_u32 m0, s18, 100352
  s_add_u32 s6, s5, 7168
  buffer_load_dwordx4 v4, s[56:59], s5 offen lds
  buffer_load_dwordx4 v4, s[56:59], s6 offen offset:1024 lds
  ds_read_b64_tr_b16 v[96:97], v12 offset:32768
  ds_read_b64_tr_b16 v[98:99], v12 offset:33280
  ds_read_b64_tr_b16 v[100:101], v13 offset:32768
  ds_read_b64_tr_b16 v[102:103], v13 offset:33280
  ds_read_b64_tr_b16 v[104:105], v12 offset:34816
  ds_read_b64_tr_b16 v[106:107], v12 offset:35328
  ds_read_b64_tr_b16 v[108:109], v13 offset:34816
  ds_read_b64_tr_b16 v[110:111], v13 offset:35328
  s_waitcnt lgkmcnt(0)
  ds_read_b64_tr_b16 v[112:113], v12 offset:36864
  ds_read_b64_tr_b16 v[114:115], v12 offset:37376
  ds_read_b64_tr_b16 v[116:117], v13 offset:36864
  ds_read_b64_tr_b16 v[118:119], v13 offset:37376
  ds_read_b64_tr_b16 v[120:121], v12 offset:38912
  ds_read_b64_tr_b16 v[122:123], v12 offset:39424
  ds_read_b64_tr_b16 v[124:125], v13 offset:38912
  ds_read_b64_tr_b16 v[126:127], v13 offset:39424
  s_waitcnt lgkmcnt(0)
  s_waitcnt vmcnt(12)
  s_barrier
  s_and_b32 s19, s49, 7
  s_mul_i32 s19, s19, 32768
  s_add_u32 s19, s19, s17
  s_lshr_b32 s49, s49, 4
  s_add_u32 s20, s19, 4096
  s_add_u32 m0, s18, 65536
  s_nop 0
  buffer_load_dwordx4 v1, s[52:55], s19 offen offset:0 sc1 lds
  buffer_load_dwordx4 v1, s[52:55], s19 offen offset:1024 sc1 lds
  buffer_load_dwordx4 v1, s[52:55], s19 offen offset:2048 sc1 lds
  buffer_load_dwordx4 v1, s[52:55], s19 offen offset:3072 sc1 lds
  s_add_u32 m0, s18, 69632
  s_nop 0
  buffer_load_dwordx4 v1, s[52:55], s20 offen offset:0 sc1 lds
  buffer_load_dwordx4 v1, s[52:55], s20 offen offset:1024 sc1 lds
  buffer_load_dwordx4 v1, s[52:55], s20 offen offset:2048 sc1 lds
  buffer_load_dwordx4 v1, s[52:55], s20 offen offset:3072 sc1 lds
  s_lshl_b32 s5, s70, 3
  s_add_u32 m0, s18, 102400
  s_add_u32 s6, s5, 7168
  buffer_load_dwordx4 v4, s[56:59], s5 offen lds
  buffer_load_dwordx4 v4, s[56:59], s6 offen offset:1024 lds
  s_lshl_b32 s5, s71, 3
  s_add_u32 m0, s18, 104448
  s_add_u32 s6, s5, 7168
  buffer_load_dwordx4 v4, s[56:59], s5 offen lds
  buffer_load_dwordx4 v4, s[56:59], s6 offen offset:1024 lds
  s_waitcnt vmcnt(12)
  ds_read_b64_tr_b16 v[128:129], v12 offset:0
  ds_read_b64_tr_b16 v[130:131], v12 offset:512
  ds_read_b64_tr_b16 v[132:133], v13 offset:0
  ds_read_b64_tr_b16 v[134:135], v13 offset:512
  ds_read_b64_tr_b16 v[136:137], v12 offset:2048
  ds_read_b64_tr_b16 v[138:139], v12 offset:2560
  ds_read_b64_tr_b16 v[140:141], v13 offset:2048
  ds_read_b64_tr_b16 v[142:143], v13 offset:2560
  s_waitcnt lgkmcnt(0)
  s_barrier
  s_and_b32 s19, s49, 7
  s_mul_i32 s19, s19, 32768
  s_add_u32 s19, s19, s17
  s_lshr_b32 s49, s49, 4
  s_add_u32 s20, s19, 4096
  s_add_u32 m0, s18, 0
  s_nop 0
  buffer_load_dwordx4 v1, s[52:55], s19 offen offset:0 sc1 lds
  buffer_load_dwordx4 v1, s[52:55], s19 offen offset:1024 sc1 lds
  buffer_load_dwordx4 v1, s[52:55], s19 offen offset:2048 sc1 lds
  buffer_load_dwordx4 v1, s[52:55], s19 offen offset:3072 sc1 lds
  s_add_u32 m0, s18, 4096
  s_nop 0
  buffer_load_dwordx4 v1, s[52:55], s20 offen offset:0 sc1 lds
  buffer_load_dwordx4 v1, s[52:55], s20 offen offset:1024 sc1 lds
  buffer_load_dwordx4 v1, s[52:55], s20 offen offset:2048 sc1 lds
  buffer_load_dwordx4 v1, s[52:55], s20 offen offset:3072 sc1 lds
  s_lshl_b32 s5, s72, 3
  s_add_u32 m0, s18, 131072
  s_add_u32 s6, s5, 7168
  buffer_load_dwordx4 v4, s[56:59], s5 offen lds
  buffer_load_dwordx4 v4, s[56:59], s6 offen offset:1024 lds
  s_lshl_b32 s5, s73, 3
  s_add_u32 m0, s18, 133120
  s_add_u32 s6, s5, 7168
  buffer_load_dwordx4 v4, s[56:59], s5 offen lds
  buffer_load_dwordx4 v4, s[56:59], s6 offen offset:1024 lds
  s_lshl_b32 s5, s74, 3
  s_add_u32 m0, s18, 135168
  s_add_u32 s6, s5, 7168
  buffer_load_dwordx4 v4, s[56:59], s5 offen lds
  buffer_load_dwordx4 v4, s[56:59], s6 offen offset:1024 lds
  s_lshl_b32 s5, s75, 3
  s_add_u32 m0, s18, 137216
  s_add_u32 s6, s5, 7168
  buffer_load_dwordx4 v4, s[56:59], s5 offen lds
  buffer_load_dwordx4 v4, s[56:59], s6 offen offset:1024 lds
  s_waitcnt vmcnt(16)
  ds_read_b64_tr_b16 v[144:145], v12 offset:4096
  ds_read_b64_tr_b16 v[146:147], v12 offset:4608
  ds_read_b64_tr_b16 v[148:149], v13 offset:4096
  ds_read_b64_tr_b16 v[150:151], v13 offset:4608
  ds_read_b64_tr_b16 v[152:153], v12 offset:6144
  ds_read_b64_tr_b16 v[154:155], v12 offset:6656
  ds_read_b64_tr_b16 v[156:157], v13 offset:6144
  ds_read_b64_tr_b16 v[158:159], v13 offset:6656
  s_waitcnt lgkmcnt(0)
  s_barrier
  s_and_b32 s19, s49, 7
  s_mul_i32 s19, s19, 32768
  s_add_u32 s19, s19, s17
  s_lshr_b32 s49, s49, 4
  s_add_u32 s20, s19, 4096
  s_add_u32 m0, s18, 32768
  s_nop 0
  buffer_load_dwordx4 v1, s[52:55], s19 offen offset:0 sc1 lds
  buffer_load_dwordx4 v1, s[52:55], s19 offen offset:1024 sc1 lds
  buffer_load_dwordx4 v1, s[52:55], s19 offen offset:2048 sc1 lds
  buffer_load_dwordx4 v1, s[52:55], s19 offen offset:3072 sc1 lds
  s_add_u32 m0, s18, 36864
  s_nop 0
  buffer_load_dwordx4 v1, s[52:55], s20 offen offset:0 sc1 lds
  buffer_load_dwordx4 v1, s[52:55], s20 offen offset:1024 sc1 lds
  buffer_load_dwordx4 v1, s[52:55], s20 offen offset:2048 sc1 lds
  buffer_load_dwordx4 v1, s[52:55], s20 offen offset:3072 sc1 lds
  s_lshl_b32 s5, s76, 3
  s_add_u32 m0, s18, 98304
  s_add_u32 s6, s5, 7168
  buffer_load_dwordx4 v4, s[56:59], s5 offen lds
  buffer_load_dwordx4 v4, s[56:59], s6 offen offset:1024 lds
  s_lshl_b32 s5, s77, 3
  s_add_u32 m0, s18, 100352
  s_add_u32 s6, s5, 7168
  buffer_load_dwordx4 v4, s[56:59], s5 offen lds
  buffer_load_dwordx4 v4, s[56:59], s6 offen offset:1024 lds
  s_lshl_b32 s5, s78, 3
  s_add_u32 m0, s18, 102400
  s_add_u32 s6, s5, 7168
  buffer_load_dwordx4 v4, s[56:59], s5 offen lds
  buffer_load_dwordx4 v4, s[56:59], s6 offen offset:1024 lds
  s_lshl_b32 s5, s79, 3
  s_add_u32 m0, s18, 104448
  s_add_u32 s6, s5, 7168
  buffer_load_dwordx4 v4, s[56:59], s5 offen lds
  buffer_load_dwordx4 v4, s[56:59], s6 offen offset:1024 lds
  s_waitcnt vmcnt(20)
  ds_read_b64_tr_b16 v[160:161], v12 offset:32768
  ds_read_b64_tr_b16 v[162:163], v12 offset:33280
  ds_read_b64_tr_b16 v[164:165], v13 offset:32768
  ds_read_b64_tr_b16 v[166:167], v13 offset:33280
  ds_read_b64_tr_b16 v[168:169], v12 offset:34816
  ds_read_b64_tr_b16 v[170:171], v12 offset:35328
  ds_read_b64_tr_b16 v[172:173], v13 offset:34816
  ds_read_b64_tr_b16 v[174:175], v13 offset:35328
  s_waitcnt lgkmcnt(0)
  s_waitcnt vmcnt(16)
  ds_read_b64_tr_b16 v[176:177], v12 offset:36864
  ds_read_b64_tr_b16 v[178:179], v12 offset:37376
  ds_read_b64_tr_b16 v[180:181], v13 offset:36864
  ds_read_b64_tr_b16 v[182:183], v13 offset:37376
  ds_read_b64_tr_b16 v[184:185], v12 offset:38912
  ds_read_b64_tr_b16 v[186:187], v12 offset:39424
  ds_read_b64_tr_b16 v[188:189], v13 offset:38912
  ds_read_b64_tr_b16 v[190:191], v13 offset:39424
  s_waitcnt lgkmcnt(0)
  s_barrier
  s_and_b32 s19, s49, 7
  s_mul_i32 s19, s19, 32768
  s_add_u32 s19, s19, s17
  s_lshr_b32 s49, s49, 4
  s_add_u32 s20, s19, 4096
  s_add_u32 m0, s18, 65536
  s_nop 0
  buffer_load_dwordx4 v1, s[52:55], s19 offen offset:0 sc1 lds
  buffer_load_dwordx4 v1, s[52:55], s19 offen offset:1024 sc1 lds
  buffer_load_dwordx4 v1, s[52:55], s19 offen offset:2048 sc1 lds
  buffer_load_dwordx4 v1, s[52:55], s19 offen offset:3072 sc1 lds
  s_add_u32 m0, s18, 69632
  s_nop 0
  buffer_load_dwordx4 v1, s[52:55], s20 offen offset:0 sc1 lds
  buffer_load_dwordx4 v1, s[52:55], s20 offen offset:1024 sc1 lds
  buffer_load_dwordx4 v1, s[52:55], s20 offen offset:2048 sc1 lds
  buffer_load_dwordx4 v1, s[52:55], s20 offen offset:3072 sc1 lds
  s_lshl_b32 s5, s80, 3
  s_add_u32 m0, s18, 131072
  s_add_u32 s6, s5, 7168
  buffer_load_dwordx4 v4, s[56:59], s5 offen lds
  buffer_load_dwordx4 v4, s[56:59], s6 offen offset:1024 lds
  s_lshl_b32 s5, s81, 3
  s_add_u32 m0, s18, 133120
  s_add_u32 s6, s5, 7168
  buffer_load_dwordx4 v4, s[56:59], s5 offen lds
  buffer_load_dwordx4 v4, s[56:59], s6 offen offset:1024 lds
  s_lshl_b32 s5, s82, 3
  s_add_u32 m0, s18, 135168
  s_add_u32 s6, s5, 7168
  buffer_load_dwordx4 v4, s[56:59], s5 offen lds
  buffer_load_dwordx4 v4, s[56:59], s6 offen offset:1024 lds
  s_lshl_b32 s5, s83, 3
  s_add_u32 m0, s18, 137216
  s_add_u32 s6, s5, 7168
  buffer_load_dwordx4 v4, s[56:59], s5 offen lds
  buffer_load_dwordx4 v4, s[56:59], s6 offen offset:1024 lds
  s_waitcnt vmcnt(20)
  ds_read_b64_tr_b16 v[192:193], v12 offset:0
  ds_read_b64_tr_b16 v[194:195], v12 offset:512
  ds_read_b64_tr_b16 v[196:197], v13 offset:0
  ds_read_b64_tr_b16 v[198:199], v13 offset:512
  ds_read_b64_tr_b16 v[200:201], v12 offset:2048
  ds_read_b64_tr_b16 v[202:203], v12 offset:2560
  ds_read_b64_tr_b16 v[204:205], v13 offset:2048
  ds_read_b64_tr_b16 v[206:207], v13 offset:2560
  s_waitcnt lgkmcnt(0)
  s_waitcnt vmcnt(16)
  ds_read_b64_tr_b16 v[208:209], v12 offset:4096
  ds_read_b64_tr_b16 v[210:211], v12 offset:4608
  ds_read_b64_tr_b16 v[212:213], v13 offset:4096
  ds_read_b64_tr_b16 v[214:215], v13 offset:4608
  ds_read_b64_tr_b16 v[216:217], v12 offset:6144
  ds_read_b64_tr_b16 v[218:219], v12 offset:6656
  ds_read_b64_tr_b16 v[220:221], v13 offset:6144
  ds_read_b64_tr_b16 v[222:223], v13 offset:6656
  s_waitcnt lgkmcnt(0)
  s_barrier
  s_lshl_b32 s5, s84, 3
  s_add_u32 m0, s18, 98304
  s_add_u32 s6, s5, 7168
  buffer_load_dwordx4 v4, s[56:59], s5 offen lds
  buffer_load_dwordx4 v4, s[56:59], s6 offen offset:1024 lds
  s_lshl_b32 s5, s85, 3
  s_add_u32 m0, s18, 100352
  s_add_u32 s6, s5, 7168
  buffer_load_dwordx4 v4, s[56:59], s5 offen lds
  buffer_load_dwordx4 v4, s[56:59], s6 offen offset:1024 lds
  s_lshl_b32 s5, s86, 3
  s_add_u32 m0, s18, 102400
  s_add_u32 s6, s5, 7168
  buffer_load_dwordx4 v4, s[56:59], s5 offen lds
  buffer_load_dwordx4 v4, s[56:59], s6 offen offset:1024 lds
  s_lshl_b32 s5, s87, 3
  s_add_u32 m0, s18, 104448
  s_add_u32 s6, s5, 7168
  buffer_load_dwordx4 v4, s[56:59], s5 offen lds
  buffer_load_dwordx4 v4, s[56:59], s6 offen offset:1024 lds
  s_lshl_b32 s5, s88, 3
  s_add_u32 m0, s18, 0
  s_add_u32 s6, s5, 7168
  buffer_load_dwordx4 v4, s[56:59], s5 offen lds
  buffer_load_dwordx4 v4, s[56:59], s6 offen offset:1024 lds
  s_lshl_b32 s5, s89, 3
  s_add_u32 m0, s18, 2048
  s_add_u32 s6, s5, 7168
  buffer_load_dwordx4 v4, s[56:59], s5 offen lds
  buffer_load_dwordx4 v4, s[56:59], s6 offen offset:1024 lds
  s_lshl_b32 s5, s90, 3
  s_add_u32 m0, s18, 4096
  s_add_u32 s6, s5, 7168
  buffer_load_dwordx4 v4, s[56:59], s5 offen lds
  buffer_load_dwordx4 v4, s[56:59], s6 offen offset:1024 lds
  s_lshl_b32 s5, s91, 3
  s_add_u32 m0, s18, 6144
  s_add_u32 s6, s5, 7168
  buffer_load_dwordx4 v4, s[56:59], s5 offen lds
  buffer_load_dwordx4 v4, s[56:59], s6 offen offset:1024 lds
  s_waitcnt vmcnt(24)
  s_barrier
  s_load_dword s36, s[46:47], s24
  s_load_dword s37, s[46:47], s25
  s_load_dword s38, s[46:47], s26
  s_branch m_spJ
m_spC:
  s_waitcnt vmcnt(0)
  s_barrier
  s_lshl_b32 s5, s68, 3
  s_add_u32 m0, s18, 98304
  s_add_u32 s6, s5, 7168
  buffer_load_dwordx4 v4, s[56:59], s5 offen lds
  buffer_load_dwordx4 v4, s[56:59], s6 offen offset:1024 lds
  s_lshl_b32 s5, s69, 3
  s_add_u32 m0, s18, 100352
  s_add_u32 s6, s5, 7168
  buffer_load_dwordx4 v4, s[56:59], s5 offen lds
  buffer_load_dwordx4 v4, s[56:59], s6 offen offset:1024 lds
  s_lshl_b32 s5, s70, 3
  s_add_u32 m0, s18, 102400
  s_add_u32 s6, s5, 7168
  buffer_load_dwordx4 v4, s[56:59], s5 offen lds
  buffer_load_dwordx4 v4, s[56:59], s6 offen offset:1024 lds
  s_lshl_b32 s5, s71, 3
  s_add_u32 m0, s18, 104448
  s_add_u32 s6, s5, 7168
  buffer_load_dwordx4 v4, s[56:59], s5 offen lds
  buffer_load_dwordx4 v4, s[56:59], s6 offen offset:1024 lds
  ds_read_b64_tr_b16 v[96:97], v12 offset:32768
  ds_read_b64_tr_b16 v[98:99], v12 offset:33280
  ds_read_b64_tr_b16 v[100:101], v13 offset:32768
  ds_read_b64_tr_b16 v[102:103], v13 offset:33280
  ds_read_b64_tr_b16 v[104:105], v12 offset:34816
  ds_read_b64_tr_b16 v[106:107], v12 offset:35328
  ds_read_b64_tr_b16 v[108:109], v13 offset:34816
  ds_read_b64_tr_b16 v[110:111], v13 offset:35328
  s_waitcnt lgkmcnt(0)
  s_lshl_b32 s5, s72, 3
  s_add_u32 m0, s18, 131072
  s_add_u32 s6, s5, 7168
  buffer_load_dwordx4 v4, s[56:59], s5 offen lds
  buffer_load_dwordx4 v4, s[56:59], s6 offen offset:1024 lds
  s_lshl_b32 s5, s73, 3
  s_add_u32 m0, s18, 133120
  s_add_u32 s6, s5, 7168
  buffer_load_dwordx4 v4, s[56:59], s5 offen lds
  buffer_load_dwordx4 v4, s[56:59], s6 offen offset:1024 lds
  ds_read_b64_tr_b16 v[112:113], v12 offset:36864
  ds_read_b64_tr_b16 v[114:115], v12 offset:37376
  ds_read_b64_tr_b16 v[116:117], v13 offset:36864
  ds_read_b64_tr_b16 v[118:119], v13 offset:37376
  ds_read_b64_tr_b16 v[120:121], v12 offset:38912
  ds_read_b64_tr_b16 v[122:123], v12 offset:39424
  ds_read_b64_tr_b16 v[124:125], v13 offset:38912
  ds_read_b64_tr_b16 v[126:127], v13 offset:39424
  s_waitcnt lgkmcnt(0)
  s_lshl_b32 s5, s74, 3
  s_add_u32 m0, s18, 135168
  s_add_u32 s6, s5, 7168
  buffer_load_dwordx4 v4, s[56:59], s5 offen lds
  buffer_load_dwordx4 v4, s[56:59], s6 offen offset:1024 lds
  s_lshl_b32 s5, s75, 3
  s_add_u32 m0, s18, 137216
  s_add_u32 s6, s5, 7168
  buffer_load_dwordx4 v4, s[56:59], s5 offen lds
  buffer_load_dwordx4 v4, s[56:59], s6 offen offset:1024 lds
  s_waitcnt vmcnt(12)
  ds_read_b64_tr_b16 v[128:129], v12 offset:0
  ds_read_b64_tr_b16 v[130:131], v12 offset:512
  ds_read_b64_tr_b16 v[132:133], v13 offset:0
  ds_read_b64_tr_b16 v[134:135], v13 offset:512
  ds_read_b64_tr_b16 v[136:137], v12 offset:2048
  ds_read_b64_tr_b16 v[138:139], v12 offset:2560
  ds_read_b64_tr_b16 v[140:141], v13 offset:2048
  ds_read_b64_tr_b16 v[142:143], v13 offset:2560
  s_waitcnt lgkmcnt(0)
  s_lshl_b32 s5, s76, 3
  s_add_u32 m0, s18, 98304
  s_add_u32 s6, s5, 7168
  buffer_load_dwordx4 v4, s[56:59], s5 offen lds
  buffer_load_dwordx4 v4, s[56:59], s6 offen offset:1024 lds
  s_lshl_b32 s5, s77, 3
  s_add_u32 m0, s18, 100352
  s_add_u32 s6, s5, 7168
  buffer_load_dwordx4 v4, s[56:59], s5 offen lds
  buffer_load_dwordx4 v4, s[56:59], s6 offen offset:1024 lds
  s_waitcnt vmcnt(12)
  ds_read_b64_tr_b16 v[144:145], v12 offset:4096
  ds_read_b64_tr_b16 v[146:147], v12 offset:4608
  ds_read_b64_tr_b16 v[148:149], v13 offset:4096
  ds_read_b64_tr_b16 v[150:151], v13 offset:4608
  ds_read_b64_tr_b16 v[152:153], v12 offset:6144
  ds_read_b64_tr_b16 v[154:155], v12 offset:6656
  ds_read_b64_tr_b16 v[156:157], v13 offset:6144
  ds_read_b64_tr_b16 v[158:159], v13 offset:6656
  s_waitcnt lgkmcnt(0)
  s_lshl_b32 s5, s78, 3
  s_add_u32 m0, s18, 102400
  s_add_u32 s6, s5, 7168
  buffer_load_dwordx4 v4, s[56:59], s5 offen lds
  buffer_load_dwordx4 v4, s[56:59], s6 offen offset:1024 lds
  s_lshl_b32 s5, s79, 3
  s_add_u32 m0, s18, 104448
  s_add_u32 s6, s5, 7168
  buffer_load_dwordx4 v4, s[56:59], s5 offen lds
  buffer_load_dwordx4 v4, s[56:59], s6 offen offset:1024 lds
  s_waitcnt vmcnt(12)
  ds_read_b64_tr_b16 v[160:161], v12 offset:32768
  ds_read_b64_tr_b16 v[162:163], v12 offset:33280
  ds_read_b64_tr_b16 v[164:165], v13 offset:32768
  ds_read_b64_tr_b16 v[166:167], v13 offset:33280
  ds_read_b64_tr_b16 v[168:169], v12 offset:34816
  ds_read_b64_tr_b16 v[170:171], v12 offset:35328
  ds_read_b64_tr_b16 v[172:173], v13 offset:34816
  ds_read_b64_tr_b16 v[174:175], v13 offset:35328
  s_waitcnt lgkmcnt(0)
  s_lshl_b32 s5, s80, 3
  s_add_u32 m0, s18, 131072
  s_add_u32 s6, s5, 7168
  buffer_load_dwordx4 v4, s[56:59], s5 offen lds
  buffer_load_dwordx4 v4, s[56:59], s6 offen offset:1024 lds
  s_lshl_b32 s5, s81, 3
  s_add_u32 m0, s18, 133120
  s_add_u32 s6, s5, 7168
  buffer_load_dwordx4 v4, s[56:59], s5 offen lds
  buffer_load_dwordx4 v4, s[56:59], s6 offen offset:1024 lds
  s_waitcnt vmcnt(12)
  ds_read_b64_tr_b16 v[176:177], v12 offset:36864
  ds_read_b64_tr_b16 v[178:179], v12 offset:37376
  ds_read_b64_tr_b16 v[180:181], v13 offset:36864
  ds_read_b64_tr_b16 v[182:183], v13 offset:37376
  ds_read_b64_tr_b16 v[184:185], v12 offset:38912
  ds_read_b64_tr_b16 v[186:187], v12 offset:39424
  ds_read_b64_tr_b16 v[188:189], v13 offset:38912
  ds_read_b64_tr_b16 v[190:191], v13 offset:39424
  s_waitcnt lgkmcnt(0)
  s_lshl_b32 s5, s82, 3
  s_add_u32 m0, s18, 135168
  s_add_u32 s6, s5, 7168
  buffer_load_dwordx4 v4, s[56:59], s5 offen lds
  buffer_load_dwordx4 v4, s[56:59], s6 offen offset:1024 lds
  s_lshl_b32 s5, s83, 3
  s_add_u32 m0, s18, 137216
  s_add_u32 s6, s5, 7168
  buffer_load_dwordx4 v4, s[56:59], s5 offen lds
  buffer_load_dwordx4 v4, s[56:59], s6 offen offset:1024 lds
  s_waitcnt vmcnt(12)
  ds_read_b64_tr_b16 v[192:193], v12 offset:0
  ds_read_b64_tr_b16 v[194:195], v12 offset:512
  ds_read_b64_tr_b16 v[196:197], v13 offset:0
  ds_read_b64_tr_b16 v[198:199], v13 offset:512
  ds_read_b64_tr_b16 v[200:201], v12 offset:2048
  ds_read_b64_tr_b16 v[202:203], v12 offset:2560
  ds_read_b64_tr_b16 v[204:205], v13 offset:2048
  ds_read_b64_tr_b16 v[206:207], v13 offset:2560
  s_waitcnt lgkmcnt(0)
  s_lshl_b32 s5, s84, 3
  s_add_u32 m0, s18, 98304
  s_add_u32 s6, s5, 7168
  buffer_load_dwordx4 v4, s[56:59], s5 offen lds
  buffer_load_dwordx4 v4, s[56:59], s6 offen offset:1024 lds
  s_lshl_b32 s5, s85, 3
  s_add_u32 m0, s18, 100352
  s_add_u32 s6, s5, 7168
  buffer_load_dwordx4 v4, s[56:59], s5 offen lds
  buffer_load_dwordx4 v4, s[56:59], s6 offen offset:1024 lds
  s_waitcnt vmcnt(12)
  ds_read_b64_tr_b16 v[208:209], v12 offset:4096
  ds_read_b64_tr_b16 v[210:211], v12 offset:4608
  ds_read_b64_tr_b16 v[212:213], v13 offset:4096
  ds_read_b64_tr_b16 v[214:215], v13 offset:4608
  ds_read_b64_tr_b16 v[216:217], v12 offset:6144
  ds_read_b64_tr_b16 v[218:219], v12 offset:6656
  ds_read_b64_tr_b16 v[220:221], v13 offset:6144
  ds_read_b64_tr_b16 v[222:223], v13 offset:6656
  s_waitcnt lgkmcnt(0)
  s_lshl_b32 s5, s86, 3
  s_add_u32 m0, s18, 102400
  s_add_u32 s6, s5, 7168
  buffer_load_dwordx4 v4, s[56:59], s5 offen lds
  buffer_load_dwordx4 v4, s[56:59], s6 offen offset:1024 lds
  s_lshl_b32 s5, s87, 3
  s_add_u32 m0, s18, 104448
  s_add_u32 s6, s5, 7168
  buffer_load_dwordx4 v4, s[56:59], s5 offen lds
  buffer_load_dwordx4 v4, s[56:59], s6 offen offset:1024 lds
  s_lshl_b32 s5, s88, 3
  s_add_u32 m0, s18, 0
  s_add_u32 s6, s5, 7168
  buffer_load_dwordx4 v4, s[56:59], s5 offen lds
  buffer_load_dwordx4 v4, s[56:59], s6 offen offset:1024 lds
  s_lshl_b32 s5, s89, 3
  s_add_u32 m0, s18, 2048
  s_add_u32 s6, s5, 7168
  buffer_load_dwordx4 v4, s[56:59], s5 offen lds
  buffer_load_dwordx4 v4, s[56:59], s6 offen offset:1024 lds
  s_lshl_b32 s5, s90, 3
  s_add_u32 m0, s18, 4096
  s_add_u32 s6, s5, 7168
  buffer_load_dwordx4 v4, s[56:59], s5 offen lds
  buffer_load_dwordx4 v4, s[56:59], s6 offen offset:1024 lds
  s_lshl_b32 s5, s91, 3
  s_add_u32 m0, s18, 6144
  s_add_u32 s6, s5, 7168
  buffer_load_dwordx4 v4, s[56:59], s5 offen lds
  buffer_load_dwordx4 v4, s[56:59], s6 offen offset:1024 lds
  s_sleep 60
  s_load_dword s36, s[46:47], s24
  s_load_dword s37, s[46:47], s25
  s_load_dword s38, s[46:47], s26
m_spJ:
  s_waitcnt lgkmcnt(0)
  s_cmp_eq_u32 s36, s48
  s_cbranch_scc1 nok9
  v_mov_b32 v248, s24
  s_mov_b64 exec, 1
  s_mov_b64 s[98:99], exec
  s_mov_b32 s97, 0
poll10:
  global_load_dword v250, v248, s[46:47] sc1
  s_add_u32 s97, s97, 1
  s_waitcnt vmcnt(0)
  v_cmp_ne_u32 vcc, s48, v250
  s_nop 0
  s_and_b64 exec, exec, vcc
  s_cbranch_execz pollx10
  s_cmp_ge_u32 s97, 524288
  s_cbranch_scc1 pollx10
  s_sleep 2
  s_branch poll10
pollx10:
  s_mov_b64 exec, s[98:99]
  s_mov_b64 exec, -1
nok9:
  buffer_load_dwordx4 v[80:83], v10, s[60:63], s64 offen sc1
  buffer_load_dwordx4 v[84:87], v11, s[60:63], s64 offen sc1
  buffer_load_dwordx4 v[88:91], v10, s[60:63], s65 offen sc1
  buffer_load_dwordx4 v[92:95], v11, s[60:63], s65 offen sc1
  buffer_load_dwordx4 v[224:227], v10, s[60:63], s66 offen sc1
  buffer_load_dwordx4 v[228:231], v11, s[60:63], s66 offen sc1
  buffer_load_dwordx4 v[232:235], v10, s[60:63], s67 offen sc1
  buffer_load_dwordx4 v[236:239], v11, s[60:63], s67 offen sc1
  s_cmp_eq_u32 s37, s48
  s_cbranch_scc1 nok11
  v_mov_b32 v248, s25
  s_mov_b64 exec, 1
  s_mov_b64 s[98:99], exec
  s_mov_b32 s97, 0
poll12:
  global_load_dword v250, v248, s[46:47] sc1
  s_add_u32 s97, s97, 1
  s_waitcnt vmcnt(0)
  v_cmp_ne_u32 vcc, s48, v250
  s_nop 0
  s_and_b64 exec, exec, vcc
  s_cbranch_execz pollx12
  s_cmp_ge_u32 s97, 524288
  s_cbranch_scc1 pollx12
  s_sleep 2
  s_branch poll12
pollx12:
  s_mov_b64 exec, s[98:99]
  s_mov_b64 exec, -1
nok11:
  buffer_load_dwordx4 v[240:243], v10, s[60:63], s68 offen sc1
  buffer_load_dwordx4 v[244:247], v11, s[60:63], s68 offen sc1
  s_lshl_b32 s6, s14, 1
  s_lshr_b32 s7, s11, 1
  s_add_u32 s19, s6, s7
  s_lshl_b32 s20, s15, 6
  s_and_b32 s7, s11, 1
  s_lshl_b32 s7, s7, 5
  s_add_u32 s20, s20, s7
  s_mul_i32 s5, s19, 32768
  s_lshl_b32 s7, s20, 6
  s_add_u32 s5, s5, s7
  s_add_u32 s5, s5, 0x380000
  s_add_u32 s52, s46, s5
  s_addc_u32 s53, s47, 0
  s_and_b32 s53, s53, 0xffff
  s_mov_b32 s54, 0x800
  s_mov_b32 s55, 0x00020000
  s_lshl_b32 s21, s11, 11
  s_add_u32 s21, s21, 32768
  v_bfe_u32 v14, v2, 2, 2
  v_lshrrev_b32 v7, 5, v2
  v_lshl_add_u32 v14, v7, 4, v14
  v_lshlrev_b32 v14, 6, v14
  v_bfe_u32 v7, v2, 4, 1
  v_lshl_add_u32 v14, v7, 5, v14
  v_and_b32 v7, 3, v2
  v_lshl_add_u32 v14, v7, 3, v14
  v_add_u32 v14, s21, v14
  s_lshl_b32 s5, s19, 8
  s_add_u32 s5, s5, 0x8000
  v_and_b32 v15, 31, v2
  v_lshl_add_u32 v15, v15, 3, s5
  s_lshl_b32 s5, s19, 15
  s_lshl_b32 s7, s20, 1
  s_add_u32 s5, s5, s7
  v_and_b32 v4, 15, v2
  v_lshlrev_b32 v4, 10, v4
  v_lshrrev_b32 v7, 4, v2
  v_lshl_add_u32 v4, v7, 4, v4
  v_add_u32 v4, s5, v4
  s_xor_b32 s6, s11, 1
  s_mul_i32 s6, s6, 12288
  s_add_u32 s6, s6, 40960
  v_add_u32 v251, s6, v3
  s_xor_b32 s6, s11, 2
  s_mul_i32 s6, s6, 12288
  s_add_u32 s6, s6, 40960
  v_add_u32 v252, s6, v3
  s_xor_b32 s6, s11, 3
  s_mul_i32 s6, s6, 12288
  s_add_u32 s6, s6, 40960
  v_add_u32 v253, s6, v3
  s_mul_i32 s6, s11, 12288
  s_add_u32 s6, s6, 40960
  v_add_u32 v249, s6, v3
  v_add_u32 v7, 16384, v4
  s_waitcnt vmcnt(8)
  v_mfma_f32_32x32x16_bf16 v[16:31], v[96:99], v[80:83], 0
  v_mfma_f32_32x32x16_bf16 v[32:47], v[100:103], v[80:83], 0
  v_mfma_f32_32x32x16_bf16 v[48:63], v[96:99], v[84:87], 0
  v_mfma_f32_32x32x16_bf16 v[64:79], v[100:103], v[84:87], 0
  buffer_load_dwordx4 v[80:83], v10, s[60:63], s69 offen sc1
  buffer_load_dwordx4 v[84:87], v11, s[60:63], s69 offen sc1
  s_waitcnt vmcnt(8)
  v_mfma_f32_32x32x16_bf16 v[16:31], v[104:107], v[88:91], v[16:31]
  v_mfma_f32_32x32x16_bf16 v[32:47], v[108:111], v[88:91], v[32:47]
  v_mfma_f32_32x32x16_bf16 v[48:63], v[104:107], v[92:95], v[48:63]
  v_mfma_f32_32x32x16_bf16 v[64:79], v[108:111], v[92:95], v[64:79]
  buffer_load_dwordx4 v[96:99], v10, s[60:63], s70 offen sc1
  buffer_load_dwordx4 v[100:103], v11, s[60:63], s70 offen sc1
  s_waitcnt vmcnt(8)
  v_mfma_f32_32x32x16_bf16 v[16:31], v[112:115], v[224:227], v[16:31]
  v_mfma_f32_32x32x16_bf16 v[32:47], v[116:119], v[224:227], v[32:47]
  v_mfma_f32_32x32x16_bf16 v[48:63], v[112:115], v[228:231], v[48:63]
  v_mfma_f32_32x32x16_bf16 v[64:79], v[116:119], v[228:231], v[64:79]
  buffer_load_dwordx4 v[88:91], v10, s[60:63], s71 offen sc1
  buffer_load_dwordx4 v[92:95], v11, s[60:63], s71 offen sc1
  s_waitcnt vmcnt(8)
  v_mfma_f32_32x32x16_bf16 v[16:31], v[120:123], v[232:235], v[16:31]
  v_mfma_f32_32x32x16_bf16 v[32:47], v[124:127], v[232:235], v[32:47]
  v_mfma_f32_32x32x16_bf16 v[48:63], v[120:123], v[236:239], v[48:63]
  v_mfma_f32_32x32x16_bf16 v[64:79], v[124:127], v[236:239], v[64:79]
  s_cmp_eq_u32 s38, s48
  s_cbranch_scc1 nok13
  v_mov_b32 v248, s26
  s_mov_b64 exec, 1
  s_mov_b64 s[98:99], exec
  s_mov_b32 s97, 0
poll14:
  global_load_dword v250, v248, s[46:47] sc1
  s_add_u32 s97, s97, 1
  s_waitcnt vmcnt(0)
  v_cmp_ne_u32 vcc, s48, v250
  s_nop 0
  s_and_b64 exec, exec, vcc
  s_cbranch_execz pollx14
  s_cmp_ge_u32 s97, 524288
  s_cbranch_scc1 pollx14
  s_sleep 2
  s_branch poll14
pollx14:
  s_mov_b64 exec, s[98:99]
  s_mov_b64 exec, -1
nok13:
  buffer_load_dwordx4 v[104:107], v10, s[60:63], s72 offen sc1
  buffer_load_dwordx4 v[108:111], v11, s[60:63], s72 offen sc1
  s_waitcnt vmcnt(8)
  v_mfma_f32_32x32x16_bf16 v[16:31], v[128:131], v[240:243], v[16:31]
  v_mfma_f32_32x32x16_bf16 v[32:47], v[132:135], v[240:243], v[32:47]
  v_mfma_f32_32x32x16_bf16 v[48:63], v[128:131], v[244:247], v[48:63]
  v_mfma_f32_32x32x16_bf16 v[64:79], v[132:135], v[244:247], v[64:79]
  buffer_load_dwordx4 v[224:227], v10, s[60:63], s73 offen sc1
  buffer_load_dwordx4 v[228:231], v11, s[60:63], s73 offen sc1
  s_waitcnt vmcnt(8)
  v_mfma_f32_32x32x16_bf16 v[16:31], v[136:139], v[80:83], v[16:31]
  v_mfma_f32_32x32x16_bf16 v[32:47], v[140:143], v[80:83], v[32:47]
  v_mfma_f32_32x32x16_bf16 v[48:63], v[136:139], v[84:87], v[48:63]
  v_mfma_f32_32x32x16_bf16 v[64:79], v[140:143], v[84:87], v[64:79]
  s_load_dword s39, s[46:47], s27
  s_load_dword s40, s[46:47], s28
  buffer_load_dwordx4 v[112:115], v10, s[60:63], s74 offen sc1
  buffer_load_dwordx4 v[116:119], v11, s[60:63], s74 offen sc1
  s_waitcnt vmcnt(8)
  v_mfma_f32_32x32x16_bf16 v[16:31], v[144:147], v[96:99], v[16:31]
  v_mfma_f32_32x32x16_bf16 v[32:47], v[148:151], v[96:99], v[32:47]
  v_mfma_f32_32x32x16_bf16 v[48:63], v[144:147], v[100:103], v[48:63]
  v_mfma_f32_32x32x16_bf16 v[64:79], v[148:151], v[100:103], v[64:79]
  buffer_load_dwordx4 v[232:235], v10, s[60:63], s75 offen sc1
  buffer_load_dwordx4 v[236:239], v11, s[60:63], s75 offen sc1
  s_waitcnt vmcnt(8)
  v_mfma_f32_32x32x16_bf16 v[16:31], v[152:155], v[88:91], v[16:31]
  v_mfma_f32_32x32x16_bf16 v[32:47], v[156:159], v[88:91], v[32:47]
  v_mfma_f32_32x32x16_bf16 v[48:63], v[152:155], v[92:95], v[48:63]
  v_mfma_f32_32x32x16_bf16 v[64:79], v[156:159], v[92:95], v[64:79]
  s_waitcnt lgkmcnt(0)
  s_cmp_eq_u32 s39, s48
  s_cbranch_scc1 nok15
  v_mov_b32 v248, s27
  s_mov_b64 exec, 1
  s_mov_b64 s[98:99], exec
  s_mov_b32 s97, 0
poll16:
  global_load_dword v250, v248, s[46:47] sc1
  s_add_u32 s97, s97, 1
  s_waitcnt vmcnt(0)
  v_cmp_ne_u32 vcc, s48, v250
  s_nop 0
  s_and_b64 exec, exec, vcc
  s_cbranch_execz pollx16
  s_cmp_ge_u32 s97, 524288
  s_cbranch_scc1 pollx16
  s_sleep 2
  s_branch poll16
pollx16:
  s_mov_b64 exec, s[98:99]
  s_mov_b64 exec, -1
nok15:
  buffer_load_dwordx4 v[120:123], v10, s[60:63], s76 offen sc1
  buffer_load_dwordx4 v[124:127], v11, s[60:63], s76 offen sc1
  s_waitcnt vmcnt(8)
  v_mfma_f32_32x32x16_bf16 v[16:31], v[160:163], v[104:107], v[16:31]
  v_mfma_f32_32x32x16_bf16 v[32:47], v[164:167], v[104:107], v[32:47]
  v_mfma_f32_32x32x16_bf16 v[48:63], v[160:163], v[108:111], v[48:63]
  v_mfma_f32_32x32x16_bf16 v[64:79], v[164:167], v[108:111], v[64:79]
  buffer_load_dwordx4 v[240:243], v10, s[60:63], s77 offen sc1
  buffer_load_dwordx4 v[244:247], v11, s[60:63], s77 offen sc1
  s_waitcnt vmcnt(8)
  v_mfma_f32_32x32x16_bf16 v[16:31], v[168:171], v[224:227], v[16:31]
  v_mfma_f32_32x32x16_bf16 v[32:47], v[172:175], v[224:227], v[32:47]
  v_mfma_f32_32x32x16_bf16 v[48:63], v[168:171], v[228:231], v[48:63]
  v_mfma_f32_32x32x16_bf16 v[64:79], v[172:175], v[228:231], v[64:79]
  buffer_load_dwordx4 v[80:83], v10, s[60:63], s78 offen sc1
  buffer_load_dwordx4 v[84:87], v11, s[60:63], s78 offen sc1
  s_waitcnt vmcnt(8)
  v_mfma_f32_32x32x16_bf16 v[16:31], v[176:179], v[112:115], v[16:31]
  v_mfma_f32_32x32x16_bf16 v[32:47], v[180:183], v[112:115], v[32:47]
  v_mfma_f32_32x32x16_bf16 v[48:63], v[176:179], v[116:119], v[48:63]
  v_mfma_f32_32x32x16_bf16 v[64:79], v[180:183], v[116:119], v[64:79]
  buffer_load_dwordx4 v[96:99], v10, s[60:63], s79 offen sc1
  buffer_load_dwordx4 v[100:103], v11, s[60:63], s79 offen sc1
  s_waitcnt vmcnt(8)
  v_mfma_f32_32x32x16_bf16 v[16:31], v[184:187], v[232:235], v[16:31]
  v_mfma_f32_32x32x16_bf16 v[32:47], v[188:191], v[232:235], v[32:47]
  v_mfma_f32_32x32x16_bf16 v[48:63], v[184:187], v[236:239], v[48:63]
  v_mfma_f32_32x32x16_bf16 v[64:79], v[188:191], v[236:239], v[64:79]
  s_cmp_eq_u32 s40, s48
  s_cbranch_scc1 nok17
  v_mov_b32 v248, s28
  s_mov_b64 exec, 1
  s_mov_b64 s[98:99], exec
  s_mov_b32 s97, 0
poll18:
  global_load_dword v250, v248, s[46:47] sc1
  s_add_u32 s97, s97, 1
  s_waitcnt vmcnt(0)
  v_cmp_ne_u32 vcc, s48, v250
  s_nop 0
  s_and_b64 exec, exec, vcc
  s_cbranch_execz pollx18
  s_cmp_ge_u32 s97, 524288
  s_cbranch_scc1 pollx18
  s_sleep 2
  s_branch poll18
pollx18:
  s_mov_b64 exec, s[98:99]
  s_mov_b64 exec, -1
nok17:
  buffer_load_dwordx4 v[88:91], v10, s[60:63], s80 offen sc1
  buffer_load_dwordx4 v[92:95], v11, s[60:63], s80 offen sc1
  s_waitcnt vmcnt(8)
  v_mfma_f32_32x32x16_bf16 v[16:31], v[192:195], v[120:123], v[16:31]
  v_mfma_f32_32x32x16_bf16 v[32:47], v[196:199], v[120:123], v[32:47]
  v_mfma_f32_32x32x16_bf16 v[48:63], v[192:195], v[124:127], v[48:63]
  v_mfma_f32_32x32x16_bf16 v[64:79], v[196:199], v[124:127], v[64:79]
  buffer_load_dwordx4 v[104:107], v10, s[60:63], s81 offen sc1
  buffer_load_dwordx4 v[108:111], v11, s[60:63], s81 offen sc1
  s_waitcnt vmcnt(8)
  v_mfma_f32_32x32x16_bf16 v[16:31], v[200:203], v[240:243], v[16:31]
  v_mfma_f32_32x32x16_bf16 v[32:47], v[204:207], v[240:243], v[32:47]
  v_mfma_f32_32x32x16_bf16 v[48:63], v[200:203], v[244:247], v[48:63]
  v_mfma_f32_32x32x16_bf16 v[64:79], v[204:207], v[244:247], v[64:79]
  s_load_dword s41, s[46:47], s29
  s_load_dword s33, s[46:47], s30
  buffer_load_dwordx4 v[160:163], v10, s[60:63], s82 offen sc1
  buffer_load_dwordx4 v[164:167], v11, s[60:63], s82 offen sc1
  s_waitcnt vmcnt(8)
  v_mfma_f32_32x32x16_bf16 v[16:31], v[208:211], v[80:83], v[16:31]
  v_mfma_f32_32x32x16_bf16 v[32:47], v[212:215], v[80:83], v[32:47]
  v_mfma_f32_32x32x16_bf16 v[48:63], v[208:211], v[84:87], v[48:63]
  v_mfma_f32_32x32x16_bf16 v[64:79], v[212:215], v[84:87], v[64:79]
  ds_read_b64_tr_b16 v[224:225], v12 offset:32768
  ds_read_b64_tr_b16 v[226:227], v12 offset:33280
  ds_read_b64_tr_b16 v[228:229], v13 offset:32768
  ds_read_b64_tr_b16 v[230:231], v13 offset:33280
  buffer_load_dwordx4 v[168:171], v10, s[60:63], s83 offen sc1
  buffer_load_dwordx4 v[172:175], v11, s[60:63], s83 offen sc1
  s_waitcnt vmcnt(8)
  v_mfma_f32_32x32x16_bf16 v[16:31], v[216:219], v[96:99], v[16:31]
  v_mfma_f32_32x32x16_bf16 v[32:47], v[220:223], v[96:99], v[32:47]
  v_mfma_f32_32x32x16_bf16 v[48:63], v[216:219], v[100:103], v[48:63]
  v_mfma_f32_32x32x16_bf16 v[64:79], v[220:223], v[100:103], v[64:79]
  ds_read_b64_tr_b16 v[112:113], v12 offset:34816
  ds_read_b64_tr_b16 v[114:115], v12 offset:35328
  ds_read_b64_tr_b16 v[116:117], v13 offset:34816
  ds_read_b64_tr_b16 v[118:119], v13 offset:35328
  s_waitcnt lgkmcnt(0)
  s_cmp_eq_u32 s41, s48
  s_cbranch_scc1 nok19
  v_mov_b32 v248, s29
  s_mov_b64 exec, 1
  s_mov_b64 s[98:99], exec
  s_mov_b32 s97, 0
poll20:
  global_load_dword v250, v248, s[46:47] sc1
  s_add_u32 s97, s97, 1
  s_waitcnt vmcnt(0)
  v_cmp_ne_u32 vcc, s48, v250
  s_nop 0
  s_and_b64 exec, exec, vcc
  s_cbranch_execz pollx20
  s_cmp_ge_u32 s97, 524288
  s_cbranch_scc1 pollx20
  s_sleep 2
  s_branch poll20
pollx20:
  s_mov_b64 exec, s[98:99]
  s_mov_b64 exec, -1
nok19:
  buffer_load_dwordx4 v[176:179], v10, s[60:63], s84 offen sc1
  buffer_load_dwordx4 v[180:183], v11, s[60:63], s84 offen sc1
  s_waitcnt vmcnt(8)
  v_mfma_f32_32x32x16_bf16 v[16:31], v[224:227], v[88:91], v[16:31]
  v_mfma_f32_32x32x16_bf16 v[32:47], v[228:231], v[88:91], v[32:47]
  v_mfma_f32_32x32x16_bf16 v[48:63], v[224:227], v[92:95], v[48:63]
  v_mfma_f32_32x32x16_bf16 v[64:79], v[228:231], v[92:95], v[64:79]
  ds_read_b64_tr_b16 v[232:233], v12 offset:36864
  ds_read_b64_tr_b16 v[234:235], v12 offset:37376
  ds_read_b64_tr_b16 v[236:237], v13 offset:36864
  ds_read_b64_tr_b16 v[238:239], v13 offset:37376
  buffer_load_dwordx4 v[184:187], v10, s[60:63], s85 offen sc1
  buffer_load_dwordx4 v[188:191], v11, s[60:63], s85 offen sc1
  s_waitcnt vmcnt(8)
  v_mfma_f32_32x32x16_bf16 v[16:31], v[112:115], v[104:107], v[16:31]
  v_mfma_f32_32x32x16_bf16 v[32:47], v[116:119], v[104:107], v[32:47]
  v_mfma_f32_32x32x16_bf16 v[48:63], v[112:115], v[108:111], v[48:63]
  v_mfma_f32_32x32x16_bf16 v[64:79], v[116:119], v[108:111], v[64:79]
  ds_read_b64_tr_b16 v[120:121], v12 offset:38912
  ds_read_b64_tr_b16 v[122:123], v12 offset:39424
  ds_read_b64_tr_b16 v[124:125], v13 offset:38912
  ds_read_b64_tr_b16 v[126:127], v13 offset:39424
  buffer_load_dwordx4 v[192:195], v10, s[60:63], s86 offen sc1
  buffer_load_dwordx4 v[196:199], v11, s[60:63], s86 offen sc1
  s_waitcnt vmcnt(8)
  s_waitcnt lgkmcnt(4)
  v_mfma_f32_32x32x16_bf16 v[16:31], v[232:235], v[160:163], v[16:31]
  v_mfma_f32_32x32x16_bf16 v[32:47], v[236:239], v[160:163], v[32:47]
  v_mfma_f32_32x32x16_bf16 v[48:63], v[232:235], v[164:167], v[48:63]
  v_mfma_f32_32x32x16_bf16 v[64:79], v[236:239], v[164:167], v[64:79]
  ds_read_b64_tr_b16 v[240:241], v12 offset:0
  ds_read_b64_tr_b16 v[242:243], v12 offset:512
  ds_read_b64_tr_b16 v[244:245], v13 offset:0
  ds_read_b64_tr_b16 v[246:247], v13 offset:512
  buffer_load_dwordx4 v[200:203], v10, s[60:63], s87 offen sc1
  buffer_load_dwordx4 v[204:207], v11, s[60:63], s87 offen sc1
  s_waitcnt vmcnt(8)
  s_waitcnt lgkmcnt(4)
  v_mfma_f32_32x32x16_bf16 v[16:31], v[120:123], v[168:171], v[16:31]
  v_mfma_f32_32x32x16_bf16 v[32:47], v[124:127], v[168:171], v[32:47]
  v_mfma_f32_32x32x16_bf16 v[48:63], v[120:123], v[172:175], v[48:63]
  v_mfma_f32_32x32x16_bf16 v[64:79], v[124:127], v[172:175], v[64:79]
  ds_read_b64_tr_b16 v[80:81], v12 offset:2048
  ds_read_b64_tr_b16 v[82:83], v12 offset:2560
  ds_read_b64_tr_b16 v[84:85], v13 offset:2048
  ds_read_b64_tr_b16 v[86:87], v13 offset:2560
  s_cmp_eq_u32 s33, s48
  s_cbranch_scc1 nok21
  v_mov_b32 v248, s30
  s_mov_b64 exec, 1
  s_mov_b64 s[98:99], exec
  s_mov_b32 s97, 0
poll22:
  global_load_dword v250, v248, s[46:47] sc1
  s_add_u32 s97, s97, 1
  s_waitcnt vmcnt(0)
  v_cmp_ne_u32 vcc, s48, v250
  s_nop 0
  s_and_b64 exec, exec, vcc
  s_cbranch_execz pollx22
  s_cmp_ge_u32 s97, 524288
  s_cbranch_scc1 pollx22
  s_sleep 2
  s_branch poll22
pollx22:
  s_mov_b64 exec, s[98:99]
  s_mov_b64 exec, -1
nok21:
  buffer_load_dwordx4 v[208:211], v10, s[60:63], s88 offen sc1
  buffer_load_dwordx4 v[212:215], v11, s[60:63], s88 offen sc1
  s_waitcnt vmcnt(8)
  s_waitcnt lgkmcnt(4)
  v_mfma_f32_32x32x16_bf16 v[16:31], v[240:243], v[176:179], v[16:31]
  v_mfma_f32_32x32x16_bf16 v[32:47], v[244:247], v[176:179], v[32:47]
  v_mfma_f32_32x32x16_bf16 v[48:63], v[240:243], v[180:183], v[48:63]
  v_mfma_f32_32x32x16_bf16 v[64:79], v[244:247], v[180:183], v[64:79]
  s_barrier
  s_mov_b32 m0, s21
  s_nop 0
  buffer_load_dwordx4 v3, s[52:55], 0 offen sc1 lds
  buffer_load_dwordx4 v3, s[52:55], 0 offen offset:1024 sc1 lds
  global_load_dwordx2 v[152:153], v15, s[46:47] sc1
  ds_read_b64_tr_b16 v[96:97], v12 offset:4096
  ds_read_b64_tr_b16 v[98:99], v12 offset:4608
  ds_read_b64_tr_b16 v[100:101], v13 offset:4096
  ds_read_b64_tr_b16 v[102:103], v13 offset:4608
  buffer_load_dwordx4 v[216:219], v10, s[60:63], s89 offen sc1
  buffer_load_dwordx4 v[220:223], v11, s[60:63], s89 offen sc1
  s_waitcnt vmcnt(11)
  s_waitcnt lgkmcnt(4)
  v_mfma_f32_32x32x16_bf16 v[16:31], v[80:83], v[184:187], v[16:31]
  v_mfma_f32_32x32x16_bf16 v[32:47], v[84:87], v[184:187], v[32:47]
  v_mfma_f32_32x32x16_bf16 v[48:63], v[80:83], v[188:191], v[48:63]
  v_mfma_f32_32x32x16_bf16 v[64:79], v[84:87], v[188:191], v[64:79]
  ds_read_b64_tr_b16 v[88:89], v12 offset:6144
  ds_read_b64_tr_b16 v[90:91], v12 offset:6656
  ds_read_b64_tr_b16 v[92:93], v13 offset:6144
  ds_read_b64_tr_b16 v[94:95], v13 offset:6656
  buffer_load_dwordx4 v[224:227], v10, s[60:63], s90 offen sc1
  buffer_load_dwordx4 v[228:231], v11, s[60:63], s90 offen sc1
  s_waitcnt vmcnt(11)
  s_waitcnt lgkmcnt(4)
  v_mfma_f32_32x32x16_bf16 v[16:31], v[96:99], v[192:195], v[16:31]
  v_mfma_f32_32x32x16_bf16 v[32:47], v[100:103], v[192:195], v[32:47]
  v_mfma_f32_32x32x16_bf16 v[48:63], v[96:99], v[196:199], v[48:63]
  v_mfma_f32_32x32x16_bf16 v[64:79], v[100:103], v[196:199], v[64:79]
  ds_read_b64_tr_b16 v[104:105], v8 offset:0
  ds_read_b64_tr_b16 v[106:107], v8 offset:512
  ds_read_b64_tr_b16 v[108:109], v9 offset:0
  ds_read_b64_tr_b16 v[110:111], v9 offset:512
  ds_read_b64_tr_b16 v[112:113], v8 offset:2048
  ds_read_b64_tr_b16 v[114:115], v8 offset:2560
  ds_read_b64_tr_b16 v[116:117], v9 offset:2048
  ds_read_b64_tr_b16 v[118:119], v9 offset:2560
  buffer_load_dwordx4 v[160:163], v10, s[60:63], s91 offen sc1
  buffer_load_dwordx4 v[164:167], v11, s[60:63], s91 offen sc1
  s_waitcnt vmcnt(11)
  s_waitcnt lgkmcnt(8)
  v_mfma_f32_32x32x16_bf16 v[16:31], v[88:91], v[200:203], v[16:31]
  v_mfma_f32_32x32x16_bf16 v[32:47], v[92:95], v[200:203], v[32:47]
  v_mfma_f32_32x32x16_bf16 v[48:63], v[88:91], v[204:207], v[48:63]
  v_mfma_f32_32x32x16_bf16 v[64:79], v[92:95], v[204:207], v[64:79]
  ds_read_b64_tr_b16 v[232:233], v8 offset:4096
  ds_read_b64_tr_b16 v[234:235], v8 offset:4608
  ds_read_b64_tr_b16 v[236:237], v9 offset:4096
  ds_read_b64_tr_b16 v[238:239], v9 offset:4608
  ds_read_b64_tr_b16 v[168:169], v8 offset:6144
  ds_read_b64_tr_b16 v[170:171], v8 offset:6656
  ds_read_b64_tr_b16 v[172:173], v9 offset:6144
  ds_read_b64_tr_b16 v[174:175], v9 offset:6656
  s_waitcnt vmcnt(9)
  s_waitcnt lgkmcnt(12)
  v_mfma_f32_32x32x16_bf16 v[64:79], v[108:111], v[212:215], v[64:79]
  s_waitcnt vmcnt(4)
  s_waitcnt lgkmcnt(8)
  v_mfma_f32_32x32x16_bf16 v[64:79], v[116:119], v[220:223], v[64:79]
  s_waitcnt vmcnt(2)
  s_waitcnt lgkmcnt(4)
  v_mfma_f32_32x32x16_bf16 v[64:79], v[236:239], v[228:231], v[64:79]
  s_waitcnt vmcnt(0)
  s_waitcnt lgkmcnt(0)
  v_mfma_f32_32x32x16_bf16 v[64:79], v[172:175], v[164:167], v[64:79]
  ds_read_b64_tr_b16 v[144:145], v14 offset:0
  ds_read_b64_tr_b16 v[146:147], v14 offset:256
  ds_read_b64_tr_b16 v[148:149], v14 offset:512
  ds_read_b64_tr_b16 v[150:151], v14 offset:768
  v_mfma_f32_32x32x16_bf16 v[48:63], v[104:107], v[212:215], v[48:63]
  v_mfma_f32_32x32x16_bf16 v[48:63], v[112:115], v[220:223], v[48:63]
  s_nop 5
  ds_write_b128 v253, v[64:67] offset:8192
  ds_write_b128 v253, v[68:71] offset:9216
  v_mfma_f32_32x32x16_bf16 v[48:63], v[232:235], v[228:231], v[48:63]
  ds_write_b128 v253, v[72:75] offset:10240
  v_mfma_f32_32x32x16_bf16 v[48:63], v[168:171], v[164:167], v[48:63]
  ds_write_b128 v253, v[76:79] offset:11264
  v_mfma_f32_32x32x16_bf16 v[32:47], v[108:111], v[208:211], v[32:47]
  s_waitcnt lgkmcnt(4)
  v_lshlrev_b32 v128, 16, v144
  v_and_b32 v129, s4, v144
  v_lshlrev_b32 v130, 16, v145
  v_and_b32 v131, s4, v145
  v_mfma_f32_32x32x16_bf16 v[32:47], v[116:119], v[216:219], v[32:47]
  v_lshlrev_b32 v132, 16, v146
  v_and_b32 v133, s4, v146
  v_lshlrev_b32 v134, 16, v147
  v_and_b32 v135, s4, v147
  ds_write_b128 v252, v[48:51] offset:4096
  ds_write_b128 v252, v[52:55] offset:5120
  v_mfma_f32_32x32x16_bf16 v[32:47], v[236:239], v[224:227], v[32:47]
  ds_write_b128 v252, v[56:59] offset:6144
  v_mfma_f32_32x32x16_bf16 v[32:47], v[172:175], v[160:163], v[32:47]
  ds_write_b128 v252, v[60:63] offset:7168
  v_mfma_f32_32x32x16_bf16 v[16:31], v[104:107], v[208:211], v[16:31]
  v_lshlrev_b32 v136, 16, v148
  v_and_b32 v137, s4, v148
  v_lshlrev_b32 v138, 16, v149
  v_and_b32 v139, s4, v149
  v_mfma_f32_32x32x16_bf16 v[16:31], v[112:115], v[216:219], v[16:31]
  v_lshlrev_b32 v140, 16, v150
  v_and_b32 v141, s4, v150
  v_lshlrev_b32 v142, 16, v151
  v_and_b32 v143, s4, v151
  s_nop 0
  ds_write_b128 v251, v[32:35] offset:0
  ds_write_b128 v251, v[36:39] offset:1024
  v_mfma_f32_32x32x16_bf16 v[16:31], v[232:235], v[224:227], v[16:31]
  ds_write_b128 v251, v[40:43] offset:2048
  v_mfma_f32_32x32x16_bf16 v[16:31], v[168:171], v[160:163], v[16:31]
  ds_write_b128 v251, v[44:47] offset:3072
  v_cmp_ne_u32 vcc, s48, v153
  s_cbranch_vccz cok23
  s_mov_b64 s[98:99], exec
  s_mov_b32 s97, 0
poll24:
  global_load_dwordx2 v[152:153], v15, s[46:47] sc1
  s_add_u32 s97, s97, 1
  s_waitcnt vmcnt(0)
  v_cmp_ne_u32 vcc, s48, v153
  s_nop 0
  s_and_b64 exec, exec, vcc
  s_cbranch_execz pollx24
  s_cmp_ge_u32 s97, 524288
  s_cbranch_scc1 pollx24
  s_sleep 1
  s_branch poll24
pollx24:
  s_mov_b64 exec, s[98:99]
cok23:
  s_waitcnt lgkmcnt(0)
  s_barrier
  ds_read_b128 v[160:163], v249 offset:0
  ds_read_b128 v[164:167], v249 offset:1024
  ds_read_b128 v[168:171], v249 offset:2048
  ds_read_b128 v[172:175], v249 offset:3072
  ds_read_b128 v[176:179], v249 offset:4096
  ds_read_b128 v[180:183], v249 offset:5120
  ds_read_b128 v[184:187], v249 offset:6144
  ds_read_b128 v[188:191], v249 offset:7168
  ds_read_b128 v[192:195], v249 offset:8192
  ds_read_b128 v[196:199], v249 offset:9216
  ds_read_b128 v[200:203], v249 offset:10240
  ds_read_b128 v[204:207], v249 offset:11264
  s_waitcnt lgkmcnt(8)
  v_pk_add_f32 v[16:17], v[16:17], v[160:161]
  v_pk_add_f32 v[18:19], v[18:19], v[162:163]
  v_pk_add_f32 v[20:21], v[20:21], v[164:165]
  v_pk_add_f32 v[22:23], v[22:23], v[166:167]
  v_pk_add_f32 v[24:25], v[24:25], v[168:169]
  v_pk_add_f32 v[26:27], v[26:27], v[170:171]
  v_pk_add_f32 v[28:29], v[28:29], v[172:173]
  v_pk_add_f32 v[30:31], v[30:31], v[174:175]
  s_waitcnt lgkmcnt(4)
  v_pk_add_f32 v[16:17], v[16:17], v[176:177]
  v_pk_add_f32 v[18:19], v[18:19], v[178:179]
  v_pk_add_f32 v[20:21], v[20:21], v[180:181]
  v_pk_add_f32 v[22:23], v[22:23], v[182:183]
  v_pk_add_f32 v[24:25], v[24:25], v[184:185]
  v_pk_add_f32 v[26:27], v[26:27], v[186:187]
  v_pk_add_f32 v[28:29], v[28:29], v[188:189]
  v_pk_add_f32 v[30:31], v[30:31], v[190:191]
  s_waitcnt lgkmcnt(0)
  v_pk_add_f32 v[16:17], v[16:17], v[192:193]
  v_pk_add_f32 v[18:19], v[18:19], v[194:195]
  v_pk_add_f32 v[20:21], v[20:21], v[196:197]
  v_pk_add_f32 v[22:23], v[22:23], v[198:199]
  v_pk_add_f32 v[24:25], v[24:25], v[200:201]
  v_pk_add_f32 v[26:27], v[26:27], v[202:203]
  v_pk_add_f32 v[28:29], v[28:29], v[204:205]
  v_pk_add_f32 v[30:31], v[30:31], v[206:207]
  v_pk_fma_f32 v[16:17], v[16:17], v[152:153], v[128:129] op_sel:[0,0,0] op_sel_hi:[1,0,1]
  v_pk_fma_f32 v[18:19], v[18:19], v[152:153], v[130:131] op_sel:[0,0,0] op_sel_hi:[1,0,1]
  v_pk_fma_f32 v[20:21], v[20:21], v[152:153], v[132:133] op_sel:[0,0,0] op_sel_hi:[1,0,1]
  v_pk_fma_f32 v[22:23], v[22:23], v[152:153], v[134:135] op_sel:[0,0,0] op_sel_hi:[1,0,1]
  v_pk_fma_f32 v[24:25], v[24:25], v[152:153], v[136:137] op_sel:[0,0,0] op_sel_hi:[1,0,1]
  v_pk_fma_f32 v[26:27], v[26:27], v[152:153], v[138:139] op_sel:[0,0,0] op_sel_hi:[1,0,1]
  v_pk_fma_f32 v[28:29], v[28:29], v[152:153], v[140:141] op_sel:[0,0,0] op_sel_hi:[1,0,1]
  v_pk_fma_f32 v[30:31], v[30:31], v[152:153], v[142:143] op_sel:[0,0,0] op_sel_hi:[1,0,1]
  v_cvt_pk_bf16_f32 v144, v16, v17
  v_cvt_pk_bf16_f32 v145, v18, v19
  v_cvt_pk_bf16_f32 v146, v20, v21
  v_cvt_pk_bf16_f32 v147, v22, v23
  v_cvt_pk_bf16_f32 v148, v24, v25
  v_cvt_pk_bf16_f32 v149, v26, v27
  v_cvt_pk_bf16_f32 v150, v28, v29
  v_cvt_pk_bf16_f32 v151, v30, v31
  v_permlane16_swap_b32 v144, v148
  v_permlane16_swap_b32 v145, v149
  v_permlane16_swap_b32 v146, v150
  v_permlane16_swap_b32 v147, v151
  global_store_dwordx4 v4, v[144:147], s[42:43] sc0 sc1
  global_store_dwordx4 v7, v[148:151], s[42:43] sc0 sc1
  s_or_b32 s5, s2, s11
  s_cmp_lg_u32 s5, 0
  s_cbranch_scc1 m_noep
  s_mov_b32 s5, 0xc000
  v_mov_b32 v8, s5
  v_mov_b32 v9, s48
  s_mov_b64 exec, 1
  global_store_dword v8, v9, s[46:47] sc1
  s_mov_b64 exec, -1
m_noep:
  s_endpgm
h_spare:
  s_barrier
  s_waitcnt vmcnt(0)
  v_mov_b32 v8, s22
  v_mov_b32 v9, s48
  s_mov_b64 exec, 1
  global_store_dword v8, v9, s[46:47] sc1
  s_mov_b64 exec, -1
  s_cmp_ge_u32 s11, 2
  s_cbranch_scc1 k_done
  v_bfe_u32 v6, v2, 2, 2
  v_lshrrev_b32 v8, 5, v2
  v_lshl_add_u32 v6, v8, 3, v6
  v_lshlrev_b32 v6, 6, v6
  v_bfe_u32 v7, v2, 4, 1
  v_xor_b32 v7, v7, v8
  v_lshl_add_u32 v6, v7, 5, v6
  v_and_b32 v7, 3, v2
  v_lshl_add_u32 v12, v7, 3, v6
  s_barrier
  s_barrier
  s_barrier
  s_cmp_eq_u32 s11, 0
  s_cbranch_scc1 v_a
  s_barrier
v_a:
  s_lshl_b32 s5, s11, 15
  s_add_u32 s5, s5, 32768
  v_add_u32 v12, s5, v12
  ds_read_b64_tr_b16 v[96:97], v12 offset:0
  ds_read_b64_tr_b16 v[98:99], v12 offset:256
  ds_read_b64_tr_b16 v[100:101], v12 offset:1024
  ds_read_b64_tr_b16 v[102:103], v12 offset:1280
  ds_read_b64_tr_b16 v[104:105], v12 offset:2048
  ds_read_b64_tr_b16 v[106:107], v12 offset:2304
  ds_read_b64_tr_b16 v[108:109], v12 offset:3072
  ds_read_b64_tr_b16 v[110:111], v12 offset:3328
  ds_read_b64_tr_b16 v[112:113], v12 offset:4096
  ds_read_b64_tr_b16 v[114:115], v12 offset:4352
  ds_read_b64_tr_b16 v[116:117], v12 offset:5120
  ds_read_b64_tr_b16 v[118:119], v12 offset:5376
  ds_read_b64_tr_b16 v[120:121], v12 offset:6144
  ds_read_b64_tr_b16 v[122:123], v12 offset:6400
  ds_read_b64_tr_b16 v[124:125], v12 offset:7168
  ds_read_b64_tr_b16 v[126:127], v12 offset:7424
  ds_read_b64_tr_b16 v[128:129], v12 offset:8192
  ds_read_b64_tr_b16 v[130:131], v12 offset:8448
  ds_read_b64_tr_b16 v[132:133], v12 offset:9216
  ds_read_b64_tr_b16 v[134:135], v12 offset:9472
  ds_read_b64_tr_b16 v[136:137], v12 offset:10240
  ds_read_b64_tr_b16 v[138:139], v12 offset:10496
  ds_read_b64_tr_b16 v[140:141], v12 offset:11264
  ds_read_b64_tr_b16 v[142:143], v12 offset:11520
  ds_read_b64_tr_b16 v[144:145], v12 offset:12288
  ds_read_b64_tr_b16 v[146:147], v12 offset:12544
  ds_read_b64_tr_b16 v[148:149], v12 offset:13312
  ds_read_b64_tr_b16 v[150:151], v12 offset:13568
  ds_read_b64_tr_b16 v[152:153], v12 offset:14336
  ds_read_b64_tr_b16 v[154:155], v12 offset:14592
  ds_read_b64_tr_b16 v[156:157], v12 offset:15360
  ds_read_b64_tr_b16 v[158:159], v12 offset:15616
  ds_read_b64_tr_b16 v[160:161], v12 offset:16384
  ds_read_b64_tr_b16 v[162:163], v12 offset:16640
  ds_read_b64_tr_b16 v[164:165], v12 offset:17408
  ds_read_b64_tr_b16 v[166:167], v12 offset:17664
  ds_read_b64_tr_b16 v[168:169], v12 offset:18432
  ds_read_b64_tr_b16 v[170:171], v12 offset:18688
  ds_read_b64_tr_b16 v[172:173], v12 offset:19456
  ds_read_b64_tr_b16 v[174:175], v12 offset:19712
  ds_read_b64_tr_b16 v[176:177], v12 offset:20480
  ds_read_b64_tr_b16 v[178:179], v12 offset:20736
  ds_read_b64_tr_b16 v[180:181], v12 offset:21504
  ds_read_b64_tr_b16 v[182:183], v12 offset:21760
  ds_read_b64_tr_b16 v[184:185], v12 offset:22528
  ds_read_b64_tr_b16 v[186:187], v12 offset:22784
  ds_read_b64_tr_b16 v[188:189], v12 offset:23552
  ds_read_b64_tr_b16 v[190:191], v12 offset:23808
  ds_read_b64_tr_b16 v[192:193], v12 offset:24576
  ds_read_b64_tr_b16 v[194:195], v12 offset:24832
  ds_read_b64_tr_b16 v[196:197], v12 offset:25600
  ds_read_b64_tr_b16 v[198:199], v12 offset:25856
  ds_read_b64_tr_b16 v[200:201], v12 offset:26624
  ds_read_b64_tr_b16 v[202:203], v12 offset:26880
  ds_read_b64_tr_b16 v[204:205], v12 offset:27648
  ds_read_b64_tr_b16 v[206:207], v12 offset:27904
  ds_read_b64_tr_b16 v[208:209], v12 offset:28672
  ds_read_b64_tr_b16 v[210:211], v12 offset:28928
  ds_read_b64_tr_b16 v[212:213], v12 offset:29696
  ds_read_b64_tr_b16 v[214:215], v12 offset:29952
  ds_read_b64_tr_b16 v[216:217], v12 offset:30720
  ds_read_b64_tr_b16 v[218:219], v12 offset:30976
  ds_read_b64_tr_b16 v[220:221], v12 offset:31744
  ds_read_b64_tr_b16 v[222:223], v12 offset:32000
  s_waitcnt lgkmcnt(0)
  s_cmp_lg_u32 s11, 0
  s_cbranch_scc1 v_b
  s_barrier
v_b:
  v_dot2_f32_bf16 v16, v96, s21, 0
  v_dot2_f32_bf16 v18, v96, v96, 0
  v_dot2_f32_bf16 v17, v97, s21, 0
  v_dot2_f32_bf16 v19, v97, v97, 0
  v_dot2_f32_bf16 v16, v98, s21, v16
  v_dot2_f32_bf16 v18, v98, v98, v18
  v_dot2_f32_bf16 v17, v99, s21, v17
  v_dot2_f32_bf16 v19, v99, v99, v19
  v_dot2_f32_bf16 v16, v100, s21, v16
  v_dot2_f32_bf16 v18, v100, v100, v18
  v_dot2_f32_bf16 v17, v101, s21, v17
  v_dot2_f32_bf16 v19, v101, v101, v19
  v_dot2_f32_bf16 v16, v102, s21, v16
  v_dot2_f32_bf16 v18, v102, v102, v18
  v_dot2_f32_bf16 v17, v103, s21, v17
  v_dot2_f32_bf16 v19, v103, v103, v19
  v_dot2_f32_bf16 v16, v104, s21, v16
  v_dot2_f32_bf16 v18, v104, v104, v18
  v_dot2_f32_bf16 v17, v105, s21, v17
  v_dot2_f32_bf16 v19, v105, v105, v19
  v_dot2_f32_bf16 v16, v106, s21, v16
  v_dot2_f32_bf16 v18, v106, v106, v18
  v_dot2_f32_bf16 v17, v107, s21, v17
  v_dot2_f32_bf16 v19, v107, v107, v19
  v_dot2_f32_bf16 v16, v108, s21, v16
  v_dot2_f32_bf16 v18, v108, v108, v18
  v_dot2_f32_bf16 v17, v109, s21, v17
  v_dot2_f32_bf16 v19, v109, v109, v19
  v_dot2_f32_bf16 v16, v110, s21, v16
  v_dot2_f32_bf16 v18, v110, v110, v18
  v_dot2_f32_bf16 v17, v111, s21, v17
  v_dot2_f32_bf16 v19, v111, v111, v19
  v_dot2_f32_bf16 v16, v112, s21, v16
  v_dot2_f32_bf16 v18, v112, v112, v18
  v_dot2_f32_bf16 v17, v113, s21, v17
  v_dot2_f32_bf16 v19, v113, v113, v19
  v_dot2_f32_bf16 v16, v114, s21, v16
  v_dot2_f32_bf16 v18, v114, v114, v18
  v_dot2_f32_bf16 v17, v115, s21, v17
  v_dot2_f32_bf16 v19, v115, v115, v19
  v_dot2_f32_bf16 v16, v116, s21, v16
  v_dot2_f32_bf16 v18, v116, v116, v18
  v_dot2_f32_bf16 v17, v117, s21, v17
  v_dot2_f32_bf16 v19, v117, v117, v19
  v_dot2_f32_bf16 v16, v118, s21, v16
  v_dot2_f32_bf16 v18, v118, v118, v18
  v_dot2_f32_bf16 v17, v119, s21, v17
  v_dot2_f32_bf16 v19, v119, v119, v19
  v_dot2_f32_bf16 v16, v120, s21, v16
  v_dot2_f32_bf16 v18, v120, v120, v18
  v_dot2_f32_bf16 v17, v121, s21, v17
  v_dot2_f32_bf16 v19, v121, v121, v19
  v_dot2_f32_bf16 v16, v122, s21, v16
  v_dot2_f32_bf16 v18, v122, v122, v18
  v_dot2_f32_bf16 v17, v123, s21, v17
  v_dot2_f32_bf16 v19, v123, v123, v19
  v_dot2_f32_bf16 v16, v124, s21, v16
  v_dot2_f32_bf16 v18, v124, v124, v18
  v_dot2_f32_bf16 v17, v125, s21, v17
  v_dot2_f32_bf16 v19, v125, v125, v19
  v_dot2_f32_bf16 v16, v126, s21, v16
  v_dot2_f32_bf16 v18, v126, v126, v18
  v_dot2_f32_bf16 v17, v127, s21, v17
  v_dot2_f32_bf16 v19, v127, v127, v19
  v_dot2_f32_bf16 v16, v128, s21, v16
  v_dot2_f32_bf16 v18, v128, v128, v18
  v_dot2_f32_bf16 v17, v129, s21, v17
  v_dot2_f32_bf16 v19, v129, v129, v19
  v_dot2_f32_bf16 v16, v130, s21, v16
  v_dot2_f32_bf16 v18, v130, v130, v18
  v_dot2_f32_bf16 v17, v131, s21, v17
  v_dot2_f32_bf16 v19, v131, v131, v19
  v_dot2_f32_bf16 v16, v132, s21, v16
  v_dot2_f32_bf16 v18, v132, v132, v18
  v_dot2_f32_bf16 v17, v133, s21, v17
  v_dot2_f32_bf16 v19, v133, v133, v19
  v_dot2_f32_bf16 v16, v134, s21, v16
  v_dot2_f32_bf16 v18, v134, v134, v18
  v_dot2_f32_bf16 v17, v135, s21, v17
  v_dot2_f32_bf16 v19, v135, v135, v19
  v_dot2_f32_bf16 v16, v136, s21, v16
  v_dot2_f32_bf16 v18, v136, v136, v18
  v_dot2_f32_bf16 v17, v137, s21, v17
  v_dot2_f32_bf16 v19, v137, v137, v19
  v_dot2_f32_bf16 v16, v138, s21, v16
  v_dot2_f32_bf16 v18, v138, v138, v18
  v_dot2_f32_bf16 v17, v139, s21, v17
  v_dot2_f32_bf16 v19, v139, v139, v19
  v_dot2_f32_bf16 v16, v140, s21, v16
  v_dot2_f32_bf16 v18, v140, v140, v18
  v_dot2_f32_bf16 v17, v141, s21, v17
  v_dot2_f32_bf16 v19, v141, v141, v19
  v_dot2_f32_bf16 v16, v142, s21, v16
  v_dot2_f32_bf16 v18, v142, v142, v18
  v_dot2_f32_bf16 v17, v143, s21, v17
  v_dot2_f32_bf16 v19, v143, v143, v19
  v_dot2_f32_bf16 v16, v144, s21, v16
  v_dot2_f32_bf16 v18, v144, v144, v18
  v_dot2_f32_bf16 v17, v145, s21, v17
  v_dot2_f32_bf16 v19, v145, v145, v19
  v_dot2_f32_bf16 v16, v146, s21, v16
  v_dot2_f32_bf16 v18, v146, v146, v18
  v_dot2_f32_bf16 v17, v147, s21, v17
  v_dot2_f32_bf16 v19, v147, v147, v19
  v_dot2_f32_bf16 v16, v148, s21, v16
  v_dot2_f32_bf16 v18, v148, v148, v18
  v_dot2_f32_bf16 v17, v149, s21, v17
  v_dot2_f32_bf16 v19, v149, v149, v19
  v_dot2_f32_bf16 v16, v150, s21, v16
  v_dot2_f32_bf16 v18, v150, v150, v18
  v_dot2_f32_bf16 v17, v151, s21, v17
  v_dot2_f32_bf16 v19, v151, v151, v19
  v_dot2_f32_bf16 v16, v152, s21, v16
  v_dot2_f32_bf16 v18, v152, v152, v18
  v_dot2_f32_bf16 v17, v153, s21, v17
  v_dot2_f32_bf16 v19, v153, v153, v19
  v_dot2_f32_bf16 v16, v154, s21, v16
  v_dot2_f32_bf16 v18, v154, v154, v18
  v_dot2_f32_bf16 v17, v155, s21, v17
  v_dot2_f32_bf16 v19, v155, v155, v19
  v_dot2_f32_bf16 v16, v156, s21, v16
  v_dot2_f32_bf16 v18, v156, v156, v18
  v_dot2_f32_bf16 v17, v157, s21, v17
  v_dot2_f32_bf16 v19, v157, v157, v19
  v_dot2_f32_bf16 v16, v158, s21, v16
  v_dot2_f32_bf16 v18, v158, v158, v18
  v_dot2_f32_bf16 v17, v159, s21, v17
  v_dot2_f32_bf16 v19, v159, v159, v19
  v_dot2_f32_bf16 v16, v160, s21, v16
  v_dot2_f32_bf16 v18, v160, v160, v18
  v_dot2_f32_bf16 v17, v161, s21, v17
  v_dot2_f32_bf16 v19, v161, v161, v19
  v_dot2_f32_bf16 v16, v162, s21, v16
  v_dot2_f32_bf16 v18, v162, v162, v18
  v_dot2_f32_bf16 v17, v163, s21, v17
  v_dot2_f32_bf16 v19, v163, v163, v19
  v_dot2_f32_bf16 v16, v164, s21, v16
  v_dot2_f32_bf16 v18, v164, v164, v18
  v_dot2_f32_bf16 v17, v165, s21, v17
  v_dot2_f32_bf16 v19, v165, v165, v19
  v_dot2_f32_bf16 v16, v166, s21, v16
  v_dot2_f32_bf16 v18, v166, v166, v18
  v_dot2_f32_bf16 v17, v167, s21, v17
  v_dot2_f32_bf16 v19, v167, v167, v19
  v_dot2_f32_bf16 v16, v168, s21, v16
  v_dot2_f32_bf16 v18, v168, v168, v18
  v_dot2_f32_bf16 v17, v169, s21, v17
  v_dot2_f32_bf16 v19, v169, v169, v19
  v_dot2_f32_bf16 v16, v170, s21, v16
  v_dot2_f32_bf16 v18, v170, v170, v18
  v_dot2_f32_bf16 v17, v171, s21, v17
  v_dot2_f32_bf16 v19, v171, v171, v19
  v_dot2_f32_bf16 v16, v172, s21, v16
  v_dot2_f32_bf16 v18, v172, v172, v18
  v_dot2_f32_bf16 v17, v173, s21, v17
  v_dot2_f32_bf16 v19, v173, v173, v19
  v_dot2_f32_bf16 v16, v174, s21, v16
  v_dot2_f32_bf16 v18, v174, v174, v18
  v_dot2_f32_bf16 v17, v175, s21, v17
  v_dot2_f32_bf16 v19, v175, v175, v19
  v_dot2_f32_bf16 v16, v176, s21, v16
  v_dot2_f32_bf16 v18, v176, v176, v18
  v_dot2_f32_bf16 v17, v177, s21, v17
  v_dot2_f32_bf16 v19, v177, v177, v19
  v_dot2_f32_bf16 v16, v178, s21, v16
  v_dot2_f32_bf16 v18, v178, v178, v18
  v_dot2_f32_bf16 v17, v179, s21, v17
  v_dot2_f32_bf16 v19, v179, v179, v19
  v_dot2_f32_bf16 v16, v180, s21, v16
  v_dot2_f32_bf16 v18, v180, v180, v18
  v_dot2_f32_bf16 v17, v181, s21, v17
  v_dot2_f32_bf16 v19, v181, v181, v19
  v_dot2_f32_bf16 v16, v182, s21, v16
  v_dot2_f32_bf16 v18, v182, v182, v18
  v_dot2_f32_bf16 v17, v183, s21, v17
  v_dot2_f32_bf16 v19, v183, v183, v19
  v_dot2_f32_bf16 v16, v184, s21, v16
  v_dot2_f32_bf16 v18, v184, v184, v18
  v_dot2_f32_bf16 v17, v185, s21, v17
  v_dot2_f32_bf16 v19, v185, v185, v19
  v_dot2_f32_bf16 v16, v186, s21, v16
  v_dot2_f32_bf16 v18, v186, v186, v18
  v_dot2_f32_bf16 v17, v187, s21, v17
  v_dot2_f32_bf16 v19, v187, v187, v19
  v_dot2_f32_bf16 v16, v188, s21, v16
  v_dot2_f32_bf16 v18, v188, v188, v18
  v_dot2_f32_bf16 v17, v189, s21, v17
  v_dot2_f32_bf16 v19, v189, v189, v19
  v_dot2_f32_bf16 v16, v190, s21, v16
  v_dot2_f32_bf16 v18, v190, v190, v18
  v_dot2_f32_bf16 v17, v191, s21, v17
  v_dot2_f32_bf16 v19, v191, v191, v19
  v_dot2_f32_bf16 v16, v192, s21, v16
  v_dot2_f32_bf16 v18, v192, v192, v18
  v_dot2_f32_bf16 v17, v193, s21, v17
  v_dot2_f32_bf16 v19, v193, v193, v19
  v_dot2_f32_bf16 v16, v194, s21, v16
  v_dot2_f32_bf16 v18, v194, v194, v18
  v_dot2_f32_bf16 v17, v195, s21, v17
  v_dot2_f32_bf16 v19, v195, v195, v19
  v_dot2_f32_bf16 v16, v196, s21, v16
  v_dot2_f32_bf16 v18, v196, v196, v18
  v_dot2_f32_bf16 v17, v197, s21, v17
  v_dot2_f32_bf16 v19, v197, v197, v19
  v_dot2_f32_bf16 v16, v198, s21, v16
  v_dot2_f32_bf16 v18, v198, v198, v18
  v_dot2_f32_bf16 v17, v199, s21, v17
  v_dot2_f32_bf16 v19, v199, v199, v19
  v_dot2_f32_bf16 v16, v200, s21, v16
  v_dot2_f32_bf16 v18, v200, v200, v18
  v_dot2_f32_bf16 v17, v201, s21, v17
  v_dot2_f32_bf16 v19, v201, v201, v19
  v_dot2_f32_bf16 v16, v202, s21, v16
  v_dot2_f32_bf16 v18, v202, v202, v18
  v_dot2_f32_bf16 v17, v203, s21, v17
  v_dot2_f32_bf16 v19, v203, v203, v19
  v_dot2_f32_bf16 v16, v204, s21, v16
  v_dot2_f32_bf16 v18, v204, v204, v18
  v_dot2_f32_bf16 v17, v205, s21, v17
  v_dot2_f32_bf16 v19, v205, v205, v19
  v_dot2_f32_bf16 v16, v206, s21, v16
  v_dot2_f32_bf16 v18, v206, v206, v18
  v_dot2_f32_bf16 v17, v207, s21, v17
  v_dot2_f32_bf16 v19, v207, v207, v19
  v_dot2_f32_bf16 v16, v208, s21, v16
  v_dot2_f32_bf16 v18, v208, v208, v18
  v_dot2_f32_bf16 v17, v209, s21, v17
  v_dot2_f32_bf16 v19, v209, v209, v19
  v_dot2_f32_bf16 v16, v210, s21, v16
  v_dot2_f32_bf16 v18, v210, v210, v18
  v_dot2_f32_bf16 v17, v211, s21, v17
  v_dot2_f32_bf16 v19, v211, v211, v19
  v_dot2_f32_bf16 v16, v212, s21, v16
  v_dot2_f32_bf16 v18, v212, v212, v18
  v_dot2_f32_bf16 v17, v213, s21, v17
  v_dot2_f32_bf16 v19, v213, v213, v19
  v_dot2_f32_bf16 v16, v214, s21, v16
  v_dot2_f32_bf16 v18, v214, v214, v18
  v_dot2_f32_bf16 v17, v215, s21, v17
  v_dot2_f32_bf16 v19, v215, v215, v19
  v_dot2_f32_bf16 v16, v216, s21, v16
  v_dot2_f32_bf16 v18, v216, v216, v18
  v_dot2_f32_bf16 v17, v217, s21, v17
  v_dot2_f32_bf16 v19, v217, v217, v19
  v_dot2_f32_bf16 v16, v218, s21, v16
  v_dot2_f32_bf16 v18, v218, v218, v18
  v_dot2_f32_bf16 v17, v219, s21, v17
  v_dot2_f32_bf16 v19, v219, v219, v19
  v_dot2_f32_bf16 v16, v220, s21, v16
  v_dot2_f32_bf16 v18, v220, v220, v18
  v_dot2_f32_bf16 v17, v221, s21, v17
  v_dot2_f32_bf16 v19, v221, v221, v19
  v_dot2_f32_bf16 v16, v222, s21, v16
  v_dot2_f32_bf16 v18, v222, v222, v18
  v_dot2_f32_bf16 v17, v223, s21, v17
  v_dot2_f32_bf16 v19, v223, v223, v19
  s_nop 1
  v_add_f32 v16, v16, v17
  v_add_f32 v18, v18, v19
  v_mov_b32 v17, v16
  v_mov_b32 v19, v18
  s_nop 0
  v_permlane32_swap_b32 v16, v17
  v_permlane32_swap_b32 v18, v19
  v_add_f32 v16, v16, v17
  v_add_f32 v18, v18, v19
  v_mul_f32 v24, 0x3b000000, v16
  v_mul_f32 v25, 0x3b000000, v18
  v_fma_f32 v25, -v24, v24, v25
  v_max_f32 v25, 0, v25
  v_cvt_pk_bf16_f32 v24, v24, v25
  v_lshlrev_b32 v20, 16, v24
  v_and_b32 v25, 0xffff0000, v24
  v_add_f32 v25, 0x3727c5ac, v25
  v_cvt_pk_bf16_f32 v25, v25, v25
  v_lshlrev_b32 v25, 16, v25
  v_sqrt_f32 v25, v25
  s_nop 0
  v_cvt_pk_bf16_f32 v25, v25, v25
  v_lshlrev_b32 v22, 16, v25
  v_mul_f32 v22, v22, v22
  v_rcp_f32 v22, v22
  v_mov_b32 v23, s48
  s_lshl_b32 s5, s14, 1
  s_add_u32 s5, s5, s11
  s_lshl_b32 s5, s5, 8
  s_add_u32 s5, s5, 0x8000
  v_and_b32 v5, 31, v2
  v_lshl_add_u32 v5, v5, 3, s5
  s_mov_b32 exec_hi, 0
  global_store_dwordx2 v5, v[22:23], s[46:47] sc1
k_done:
  s_endpgm
k_end:
.section .rodata,"a"
.p2align 6
.amdhsa_kernel sequential_preLN__ssm_conv_s4__glu_gated_bilinear__prompt_kernel
  .amdhsa_next_free_vgpr 256
  .amdhsa_next_free_sgpr 102
  .amdhsa_accum_offset 256
  .amdhsa_group_segment_fixed_size 0
  .amdhsa_kernarg_size 128
  .amdhsa_user_sgpr_count 2
  .amdhsa_user_sgpr_kernarg_segment_ptr 1
  .amdhsa_system_sgpr_workgroup_id_x 1
  .amdhsa_float_denorm_mode_32 3
.end_amdhsa_kernel
```
